```python
import torch

def _softmax(x, axis=-1):
    return torch.softmax(x, dim=axis)
def _gelu(x):
    return torch.nn.functional.gelu(x, approximate="tanh")
def _silu(x):
    return torch.nn.functional.silu(x)
def _sigmoid(x):
    return torch.sigmoid(x)
def _layernorm(x, axis=-1, eps=1e-5):
    m = x.mean(dim=axis, keepdim=True)
    v = x.var(dim=axis, keepdim=True, unbiased=False)
    return (x - m) / torch.sqrt(v + eps)
def _scatter_add(tgt, idx, src, axis=0):
    return tgt.clone().index_add_(axis, idx, src)
def _segment_sum(src, seg, n):
    out = torch.zeros((n,) + src.shape[1:], dtype=src.dtype)
    return out.index_add_(0, seg, src)
def _pad(x, pw):
    flat = tuple(v for pair in reversed(pw) for v in pair)
    return torch.nn.functional.pad(x, flat)

kernel_name = 'gather_scatter__edge_featured_mpnn_egc__graph'

def setup_inputs():

    _w = (lambda a: (lambda t: t.to(torch.bfloat16) if t.is_floating_point() else t)(torch.as_tensor(a)))
    N, deg, D, De = 25000, 32, 64, max(16, 1)
    E = N * deg
    return {
        "x": _w((lambda *s: torch.randn(*s, dtype=torch.bfloat16) * 0.2)(N, D)),
        "e_attr": _w((lambda *s: torch.randn(*s, dtype=torch.bfloat16) * 0.2)(E, De)),
        "src": _w((lambda lo, hi, *s: torch.randint(lo, hi, s))(0, N, E).to(torch.int64)),
        "dst": _w((lambda lo, hi, *s: torch.randint(lo, hi, s))(0, N, E).to(torch.int64)),
        "u_w": _w((lambda *s: torch.randn(*s, dtype=torch.bfloat16) * 0.05)(D, D)),
        "v_w": _w((lambda *s: torch.randn(*s, dtype=torch.bfloat16) * 0.05)(D, D)),
        "g_w": _w((lambda *s: torch.randn(*s, dtype=torch.bfloat16) * 0.2)(2 * D + De, D)),
    }

def reference(x, e_attr, src, dst, u_w, v_w, g_w):
    N, D = x.shape
    g_in = torch.concatenate([x[dst], x[src], e_attr], axis=-1)
    eta = _sigmoid(g_in @ g_w)
    hv = x @ v_w
    msg = eta * hv[src]
    agg = _segment_sum(msg, dst, N)
    return _silu(x @ u_w + agg)
```

```asm
; @launch grid=(256,1,1) block=(512,1,1) lds=162304
.amdgcn_target "amdgcn-amd-amdhsa--gfx950"
.text
.globl gather_scatter__edge_featured_mpnn_egc__graph_kernel
.p2align 8
.type gather_scatter__edge_featured_mpnn_egc__graph_kernel,@function
gather_scatter__edge_featured_mpnn_egc__graph_kernel:
    s_cmp_ge_u32 s2, 256
    s_cbranch_scc1 M_end
    s_setprio 3
    s_load_dwordx16 s[4:19], s[0:1], 0
    s_load_dwordx4 s[20:23], s[0:1], 64
    v_lshrrev_b32 v220, 6, v0
    v_and_b32 v1, 63, v0
    v_lshlrev_b32 v180, 4, v0
    v_readfirstlane_b32 s52, v220
    v_mov_b32 v184, 0
    v_mov_b32 v185, 0
    v_mov_b32 v186, 0
    v_mov_b32 v187, 0
    s_mul_i32 s3, s2, 12800
    v_lshlrev_b32 v191, 4, v1
    s_cmp_lg_u32 s52, 7
    s_cbranch_scc1 P_nocpf
    s_cmp_ge_u32 s2, 32
    s_cbranch_scc1 P_nocpf
    s_getpc_b64 s[66:67]
P_pc:
    v_lshlrev_b32 v221, 7, v1
    v_min_u32 v222, M_codeend-P_pc-4, v221
    global_load_dword v254, v222, s[66:67]
    v_add_u32 v221, 8192, v221
    v_min_u32 v222, M_codeend-P_pc-4, v221
    global_load_dword v254, v222, s[66:67]
P_nocpf:
    v_lshrrev_b32 v220, 3, v0
    v_and_b32 v221, 7, v0
    v_lshlrev_b32 v221, 4, v221
    v_lshl_or_b32 v182, v220, 15, v221
    s_mov_b32 s66, 8192
    s_cmp_ge_u32 s2, 250
    s_waitcnt lgkmcnt(0)
    s_cbranch_scc1 P_spare
    s_add_u32 s44, s10, s3
    s_addc_u32 s45, s11, 0
    s_mov_b32 s46, 12800
    s_mov_b32 s47, 0x20000
    buffer_load_dwordx4 v[100:103], v180, s[44:47], 0 offen nt
    buffer_load_dwordx4 v[104:107], v180, s[44:47], s66 offen nt
    ds_write_b128 v180, v[184:187] offset:512
    ds_write_b32 v184, v184 offset:45568
    s_add_u32 s48, s8, s3
    s_addc_u32 s49, s9, 0
    s_mov_b32 s50, 12800
    s_mov_b32 s51, 0x20000
    s_waitcnt lgkmcnt(0)
    s_barrier
    buffer_load_dwordx4 v[108:111], v180, s[48:51], 0 offen nt
    buffer_load_dwordx4 v[112:115], v180, s[48:51], s66 offen nt
    s_mov_b32 s57, 85899
    s_mov_b32 s58, 144
    v_mov_b32 v181, 1
    v_mad_u32_u24 v183, v220, s58, v221
    v_lshrrev_b32 v220, 1, v0
    v_and_b32 v221, 1, v0
    v_sub_u32 v189, 0, v221
    v_lshlrev_b32 v221, 2, v221
    v_mad_u32_u24 v188, v220, s58, v221
    v_lshlrev_b32 v190, 2, v0
    v_cmp_gt_u32 vcc, 288, v0
    s_mov_b64 s[78:79], vcc
    v_add_u32 v148, 0, v190
    v_alignbit_b32 v148, v148, v148, 9
    v_add_u32 v149, 1, v190
    v_alignbit_b32 v149, v149, v149, 9
    v_add_u32 v150, 2, v190
    v_alignbit_b32 v150, v150, v150, 9
    v_add_u32 v151, 3, v190
    v_alignbit_b32 v151, v151, v151, 9
    v_add_u32 v152, 2048, v190
    v_alignbit_b32 v152, v152, v152, 9
    v_add_u32 v153, 2049, v190
    v_alignbit_b32 v153, v153, v153, 9
    v_add_u32 v154, 2050, v190
    v_alignbit_b32 v154, v154, v154, 9
    v_add_u32 v155, 2051, v190
    v_alignbit_b32 v155, v155, v155, 9
    s_bfe_u32 s3, s2, 0x50002
    s_lshl_b32 s3, s3, 3
    s_lshr_b32 s66, s2, 7
    s_lshl_b32 s66, s66, 2
    s_add_u32 s3, s3, s66
    s_and_b32 s66, s2, 3
    s_add_u32 s3, s3, s66
    s_lshl_b32 s3, s3, 7
    s_add_u32 s44, s22, s3
    s_addc_u32 s45, s23, 0
    s_mov_b32 s46, 8355968
    s_mov_b32 s47, 0x20000
    s_mul_i32 s3, s2, 25728
    s_add_u32 s3, s3, 8650752
    s_add_u32 s48, s22, s3
    s_addc_u32 s49, s23, 0
    s_mov_b32 s50, 25728
    s_mov_b32 s51, 0x20000
    s_waitcnt vmcnt(3)
    v_mul_u32_u24 v132, s57, v100
    v_mul_u32_u24 v133, s57, v101
    v_mul_u32_u24 v134, s57, v102
    v_mul_u32_u24 v135, s57, v103
    v_lshrrev_b32 v116, 18, v132
    v_and_b32 v116, 0x1ffc, v116
    ds_add_rtn_u32 v124, v116, v181 offset:512
    v_lshrrev_b32 v117, 18, v133
    v_and_b32 v117, 0x1ffc, v117
    ds_add_rtn_u32 v125, v117, v181 offset:512
    v_lshrrev_b32 v118, 18, v134
    v_and_b32 v118, 0x1ffc, v118
    ds_add_rtn_u32 v126, v118, v181 offset:512
    v_lshrrev_b32 v119, 18, v135
    v_and_b32 v119, 0x1ffc, v119
    ds_add_rtn_u32 v127, v119, v181 offset:512
    s_mov_b64 exec, s[78:79]
    s_cbranch_execz P_b1
    s_waitcnt vmcnt(2)
    v_mul_u32_u24 v136, s57, v104
    v_mul_u32_u24 v137, s57, v105
    v_mul_u32_u24 v138, s57, v106
    v_mul_u32_u24 v139, s57, v107
    v_lshrrev_b32 v120, 18, v136
    v_and_b32 v120, 0x1ffc, v120
    ds_add_rtn_u32 v128, v120, v181 offset:512
    v_lshrrev_b32 v121, 18, v137
    v_and_b32 v121, 0x1ffc, v121
    ds_add_rtn_u32 v129, v121, v181 offset:512
    v_lshrrev_b32 v122, 18, v138
    v_and_b32 v122, 0x1ffc, v122
    ds_add_rtn_u32 v130, v122, v181 offset:512
    v_lshrrev_b32 v123, 18, v139
    v_and_b32 v123, 0x1ffc, v123
    ds_add_rtn_u32 v131, v123, v181 offset:512
    v_lshrrev_b32 v136, 23, v136
    v_mul_u32_u24 v136, s58, v136
    v_and_b32 v104, 15, v104
    v_lshl_or_b32 v152, v104, 3, v152
    v_lshrrev_b32 v137, 23, v137
    v_mul_u32_u24 v137, s58, v137
    v_and_b32 v105, 15, v105
    v_lshl_or_b32 v153, v105, 3, v153
    v_lshrrev_b32 v138, 23, v138
    v_mul_u32_u24 v138, s58, v138
    v_and_b32 v106, 15, v106
    v_lshl_or_b32 v154, v106, 3, v154
    v_lshrrev_b32 v139, 23, v139
    v_mul_u32_u24 v139, s58, v139
    v_and_b32 v107, 15, v107
    v_lshl_or_b32 v155, v107, 3, v155
P_b1:
    s_mov_b64 exec, -1
    v_lshrrev_b32 v132, 23, v132
    v_mul_u32_u24 v132, s58, v132
    v_and_b32 v100, 15, v100
    v_lshl_or_b32 v148, v100, 3, v148
    v_lshrrev_b32 v133, 23, v133
    v_mul_u32_u24 v133, s58, v133
    v_and_b32 v101, 15, v101
    v_lshl_or_b32 v149, v101, 3, v149
    v_lshrrev_b32 v134, 23, v134
    v_mul_u32_u24 v134, s58, v134
    v_and_b32 v102, 15, v102
    v_lshl_or_b32 v150, v102, 3, v150
    v_lshrrev_b32 v135, 23, v135
    v_mul_u32_u24 v135, s58, v135
    v_and_b32 v103, 15, v103
    v_lshl_or_b32 v151, v103, 3, v151
    s_waitcnt lgkmcnt(0)
    s_barrier
    ds_read_b128 v[140:143], v180 offset:512
    s_waitcnt lgkmcnt(0)
    v_add_u32 v157, v140, v141
    v_add_u32 v158, v157, v142
    v_add_u32 v159, v158, v143
    s_nop 1
    v_and_b32_dpp v160, v159, v189 quad_perm:[0,0,2,2] row_mask:0xf bank_mask:0xf
    v_add_u32 v161, v160, v140
    v_add_u32 v162, v160, v157
    v_add_u32 v163, v160, v158
    ds_write_b128 v180, v[160:163] offset:512
    s_waitcnt lgkmcnt(0)
    s_barrier
    s_mov_b64 exec, s[78:79]
    ds_read_b32 v144, v120 offset:512
    ds_read_b32 v145, v121 offset:512
    ds_read_b32 v146, v122 offset:512
    ds_read_b32 v147, v123 offset:512
    s_mov_b64 exec, -1
    ds_read_b32 v140, v116 offset:512
    ds_read_b32 v141, v117 offset:512
    ds_read_b32 v142, v118 offset:512
    ds_read_b32 v143, v119 offset:512
    v_add_u32 v159, v160, v159
    v_min_u32 v156, 31, v161
    v_min_u32 v157, 31, v162
    v_min_u32 v158, 31, v163
    v_min_u32 v159, 31, v159
    v_lshl_or_b32 v156, v157, 8, v156
    v_lshl_or_b32 v158, v159, 8, v158
    v_lshl_or_b32 v156, v158, 16, v156
    ds_write_b32 v188, v156 offset:8704
    s_waitcnt vmcnt(0)
    v_lshl_or_b32 v148, v108, 7, v148
    v_lshl_or_b32 v149, v109, 7, v149
    v_lshl_or_b32 v150, v110, 7, v150
    v_lshl_or_b32 v151, v111, 7, v151
    s_waitcnt lgkmcnt(1)
    v_add_u32 v140, v140, v124
    v_add_u32 v141, v141, v125
    v_add_u32 v142, v142, v126
    v_add_u32 v143, v143, v127
    v_max3_u32 v157, v140, v141, v142
    v_max_u32 v157, v157, v143
    v_cmp_le_u32 vcc, 30, v157
    v_lshl_add_u32 v132, v140, 2, v132
    v_lshl_add_u32 v133, v141, 2, v133
    v_lshl_add_u32 v134, v142, 2, v134
    v_lshl_add_u32 v135, v143, 2, v135
    s_cmp_lg_u64 vcc, 0
    s_cbranch_scc1 P_ovf0
    ds_write_b32 v132, v148 offset:8712
    ds_write_b32 v133, v149 offset:8712
    ds_write_b32 v134, v150 offset:8712
    ds_write_b32 v135, v151 offset:8712
P_sc0:
    s_mov_b64 exec, s[78:79]
    s_cbranch_execz P_sc1
    v_lshl_or_b32 v152, v112, 7, v152
    v_lshl_or_b32 v153, v113, 7, v153
    v_lshl_or_b32 v154, v114, 7, v154
    v_lshl_or_b32 v155, v115, 7, v155
    s_waitcnt lgkmcnt(15)
    v_add_u32 v144, v144, v128
    v_add_u32 v145, v145, v129
    v_add_u32 v146, v146, v130
    v_add_u32 v147, v147, v131
    v_max3_u32 v157, v144, v145, v146
    v_max_u32 v157, v157, v147
    v_cmp_le_u32 vcc, 30, v157
    v_lshl_add_u32 v136, v144, 2, v136
    v_lshl_add_u32 v137, v145, 2, v137
    v_lshl_add_u32 v138, v146, 2, v138
    v_lshl_add_u32 v139, v147, 2, v139
    s_cmp_lg_u64 vcc, 0
    s_cbranch_scc1 P_ovf1
    ds_write_b32 v136, v152 offset:8712
    ds_write_b32 v137, v153 offset:8712
    ds_write_b32 v138, v154 offset:8712
    ds_write_b32 v139, v155 offset:8712
P_sc1:
    s_mov_b64 exec, -1
    s_waitcnt lgkmcnt(0)
    s_barrier
    ds_read_b128 v[100:103], v183 offset:8704
    ds_read_b128 v[104:107], v183 offset:17920
    ds_read_b128 v[108:111], v183 offset:27136
    ds_read_b128 v[112:115], v183 offset:36352
    ds_read_b32 v156, v184 offset:45568
    s_waitcnt lgkmcnt(4)
    buffer_store_dwordx4 v[100:103], v182, s[44:47], 0 offen sc1
    s_mov_b32 s3, 2097152
    s_waitcnt lgkmcnt(3)
    buffer_store_dwordx4 v[104:107], v182, s[44:47], s3 offen sc1
    s_mov_b32 s3, 4194304
    s_waitcnt lgkmcnt(2)
    buffer_store_dwordx4 v[108:111], v182, s[44:47], s3 offen sc1
    s_mov_b32 s3, 6291456
    s_waitcnt lgkmcnt(1)
    buffer_store_dwordx4 v[112:115], v182, s[44:47], s3 offen sc1
    s_waitcnt lgkmcnt(0)
    v_cmpx_ne_u32 vcc, 0, v156
    v_cmpx_gt_u32 vcc, 8, v0
    s_cbranch_execz P_noovn
    ds_read_b128 v[156:159], v180 offset:45568
    s_waitcnt lgkmcnt(0)
    buffer_store_dwordx4 v[156:159], v180, s[48:51], 0 offen sc1
P_noovn:
    s_mov_b64 exec, -1
P_join:
    s_mov_b32 s48, s20
    s_mov_b32 s49, s21
    s_mov_b32 s50, 256
    s_mov_b32 s51, 0x20000
    s_add_u32 s44, s22, 8388608
    s_addc_u32 s45, s23, 0
    s_mov_b32 s46, 12288
    s_mov_b32 s47, 0x20000
    s_cmp_lg_u32 s52, 0
    s_cbranch_scc1 P_nordy
    buffer_load_dword v164, v184, s[48:51], 0 offen sc1
P_nordy:
    s_waitcnt vmcnt(0)
    s_cmp_lg_u32 s52, 0
    s_barrier
    s_cbranch_scc1 P_noadd
    s_mov_b32 s56, 0x40000
P_rdy:
    v_readfirstlane_b32 s3, v164
    s_cmp_lg_u32 s3, 0
    s_cbranch_scc1 P_add
    buffer_load_dword v164, v184, s[48:51], 0 offen sc1
    s_waitcnt vmcnt(0)
    s_sub_u32 s56, s56, 1
    s_cbranch_scc0 P_rdy
P_add:
    s_and_b32 s3, s2, 15
    s_lshl_b32 s3, s3, 7
    v_mov_b32 v165, 1
    s_mov_b64 exec, 1
    buffer_atomic_add v165, v184, s[44:47], s3 offen sc0 sc1
    s_mov_b64 exec, -1
    s_branch P_rwx
P_noadd:
    s_mov_b32 s28, s16
    s_mov_b32 s29, s17
    s_mov_b32 s30, 18432
    s_mov_b32 s31, 0x20000
    s_mov_b32 s32, s14
    s_mov_b32 s33, s15
    s_mov_b32 s34, 8192
    s_mov_b32 s35, 0x20000
    s_mov_b32 s40, s12
    s_mov_b32 s41, s13
    s_mov_b32 s42, 8192
    s_mov_b32 s43, 0x20000
    s_mov_b32 s56, s52
P_rwl:
    s_lshl_b32 s3, s56, 11
    s_add_u32 m0, s3, 84992
    s_lshl_b32 s66, s56, 10
    buffer_load_dwordx4 v191, s[28:31], s3 offen lds
    buffer_load_dwordx4 v191, s[28:31], s3 offen offset:1024 lds
    s_add_u32 m0, s66, 103424
    s_add_u32 s3, s66, 14336
    buffer_load_dwordx4 v191, s[32:35], s66 offen lds
    s_add_u32 m0, s66, 111616
    s_and_b32 s67, s56, 6
    buffer_load_dwordx4 v191, s[40:43], s66 offen lds
    s_add_u32 m0, s3, 84992
    s_cmp_lg_u32 s67, 2
    s_cbranch_scc1 P_rw5
    buffer_load_dwordx4 v191, s[28:31], s3 offen lds
P_rw5:
    s_cmp_eq_u32 s56, 1
    s_mov_b32 s56, 0
    s_cbranch_scc1 P_rwl
P_rwx:
    s_mov_b32 s28, s6
    s_mov_b32 s29, s7
    s_mov_b32 s30, 25600000
    s_mov_b32 s31, 0x20000
    s_add_u32 s32, s22, 8650752
    s_addc_u32 s33, s23, 0
    s_mov_b32 s34, 6586368
    s_mov_b32 s35, 0x20000
    s_and_b32 s3, s2, 7
    s_lshl_b32 s3, s3, 5
    s_lshr_b32 s53, s2, 3
    s_add_u32 s3, s3, s53
    s_lshl_b32 s53, s3, 3
    s_lshl_b32 s3, s3, 15
    s_add_u32 s36, s22, s3
    s_addc_u32 s37, s23, 0
    s_mov_b32 s38, 32768
    s_mov_b32 s39, 0x20000
    v_and_b32 v223, 7, v1
    v_lshrrev_b32 v222, 3, v1
    v_lshlrev_b32 v56, 2, v222
    v_lshlrev_b32 v57, 2, v223
    s_mul_i32 s55, s52, 8192
    s_add_u32 s55, s55, 51712
    v_lshrrev_b32 v241, 5, v1
    v_lshlrev_b32 v242, 6, v241
    v_lshlrev_b32 v241, 4, v241
    v_min_u32 v222, 47, v1
    v_lshlrev_b32 v222, 3, v222
    ds_write_b64 v222, v[184:185] offset:0
    v_mul_u32_u24 v222, 10, v1
    v_mov_b32 v223, 0x3f80
    s_mov_b64 exec, 15
    ds_write_b16 v222, v223 offset:128
    s_mov_b64 exec, -1
    s_mul_i32 s54, s52, 3520
    s_add_u32 s54, s54, 134144
    s_add_u32 s73, s54, 2816
    s_mov_b32 s64, 0
    s_mov_b32 s57, 0x3fff80
    s_mov_b32 s58, 0x78
    s_mov_b32 s59, 0x1ffe0
    s_mov_b32 s60, 102400
    s_mov_b32 s62, 1
    s_mov_b32 s61, 0
    s_mov_b32 s71, 0
    s_mov_b32 s72, 0
    s_mov_b32 s70, 0
    s_movk_i32 s65, 0x2000
    s_sub_u32 s74, s52, 1
    s_cselect_b32 s74, 12, s74
    s_lshl_b32 s3, s52, 16
    s_or_b32 s74, s74, s3
    s_or_b32 s74, s74, 0x0c000c00
    s_mov_b32 s75, 16741632
    s_sub_u32 s76, 11, s52
    s_cmp_lt_u32 s52, 4
    s_cselect_b32 s76, s52, s76
    s_cselect_b32 s78, -1, 1
    s_cselect_b32 s79, -1, 0
    s_add_u32 s53, s53, s52
    v_mov_b32 v247, 0
    s_cmp_lg_u32 s52, 0
    s_cbranch_scc1 P_added
    s_mov_b64 exec, -1
    v_lshlrev_b32 v166, 7, v1
    v_mov_b32 v167, 1
    s_mov_b32 s41, 4096
    s_waitcnt vmcnt(0)
    v_readfirstlane_b32 s40, v165
    s_cmp_lg_u32 s40, 15
    s_cbranch_scc1 P_added
    buffer_atomic_add v167, v166, s[44:47], s41 offen sc1
P_added:
    v_mov_b32 v249, 0xfff8fff8
    ds_write_b128 v184, v[184:187] offset:496
    s_and_b32 s3, s52, 3
    s_lshl_b32 s3, s3, 2
    s_add_u32 s3, s3, 496
    v_mov_b32 v250, s3
    v_mov_b32 v251, s78
    s_lshl_b32 s3, s52, 2
    v_mov_b32 v59, s3
    v_lshlrev_b32 v52, 5, v1
    v_add_u32 v53, s54, v52
    v_lshl_add_u32 v58, v1, 3, s73
    ds_write_b128 v53, v[184:187]
    ds_write_b128 v53, v[184:187] offset:16
    v_lshl_add_u32 v221, v1, 2, s54
    v_add_u32 v220, s73, v1
    v_mov_b32 v222, 0x3fff80
    v_mov_b32 v223, 0xff
    v_lshlrev_b32 v226, 2, v0
    v_add_u32 v226, 119808, v226
    ds_write_b32 v226, v222
    ds_write_b32 v221, v222 offset:2048
    ds_write_b8 v220, v223 offset:512
    ds_write_b32 v221, v222 offset:2304
    ds_write_b8 v220, v223 offset:576
    ds_write_b32 v221, v222 offset:2560
    ds_write_b8 v220, v223 offset:640
    v_and_b32 v222, 1, v1
    v_lshlrev_b32 v240, 6, v222
    v_bfe_u32 v222, v1, 1, 1
    v_lshl_or_b32 v240, v222, 5, v240
    v_bfe_u32 v222, v1, 4, 1
    v_mul_u32_u24 v222, 0xaaaa, v222
    v_add_u32 v248, 0x4444, v222
    v_bfe_u32 v222, v1, 1, 3
    v_lshlrev_b32 v222, 4, v222
    v_xor_b32 v222, v222, v241
    v_and_b32 v223, 31, v1
    v_lshl_or_b32 v222, v223, 7, v222
    v_add_u32 v228, s55, v222
    v_xor_b32 v226, 32, v222
    v_add_u32 v229, s55, v226
    v_xor_b32 v226, 64, v222
    v_add_u32 v230, s55, v226
    v_xor_b32 v226, 0x60, v222
    v_add_u32 v231, s55, v226
    v_mul_u32_u24 v224, 1040, v223
    v_lshl_add_u32 v224, v241, 5, v224
    v_add_u32 v224, 51712, v224
    v_lshrrev_b32 v222, 2, v224
    v_lshl_or_b32 v222, v1, 18, v222
    v_add_u32 v204, 2, v222
    v_add_u32 v205, 65570, v222
    v_add_u32 v206, 131138, v222
    v_add_u32 v207, 196706, v222
    v_and_b32 v243, 0x38, v1
    v_and_b32 v220, 7, v1
    v_bfe_u32 v245, v1, 3, 1
    v_lshl_or_b32 v245, v220, 1, v245
    v_and_b32 v220, 16, v1
    v_or_b32 v245, v245, v220
    v_lshlrev_b32 v244, 2, v245
    v_or_b32 v246, v242, v220
    v_bfe_u32 v220, v1, 2, 1
    v_lshl_or_b32 v246, v220, 3, v246
    v_bfe_u32 v220, v1, 3, 1
    v_lshl_or_b32 v246, v220, 2, v246
    v_and_b32 v222, 3, v1
    v_bfe_u32 v223, v1, 2, 1
    v_lshl_or_b32 v222, v223, 3, v222
    v_bfe_u32 v223, v1, 3, 1
    v_lshl_or_b32 v2, v223, 2, v222
    s_cmp_lt_u32 s52, 6
    s_cbranch_scc1 P_noxs
    v_sub_u32 v220, 511, v0
    v_lshlrev_b32 v220, 7, v220
    s_mov_b32 s24, s4
    s_mov_b32 s25, s5
    s_mov_b32 s26, 3200000
    s_mov_b32 s27, 0x20000
    s_and_b32 s3, s53, 0x7f8
    s_mul_i32 s3, s3, 25000
    s_lshr_b32 s3, s3, 11
    s_lshl_b32 s3, s3, 7
    v_min_u32 v220, 12672, v220
    buffer_load_dword v254, v220, s[24:27], s3 offen
P_noxs:
    s_lshl_b32 s67, s52, 12
    s_mul_i32 s66, s52, 4160
    s_add_u32 s66, s66, 51712
    s_cmp_lg_u32 s52, 0
    s_cbranch_scc1 P_sync
    s_and_b32 s3, s2, 63
    s_lshl_b32 s3, s3, 7
    s_add_u32 s3, s3, 4096
    s_mov_b32 s56, 0x40000
P_poll:
    s_load_dword s68, s[44:45], s3 glc
    s_waitcnt lgkmcnt(0)
    s_sub_u32 s56, s56, 1
    s_cbranch_scc1 P_sync
    s_cmp_lg_u32 s68, 16
    s_cbranch_scc1 P_poll
P_sync:
    s_mov_b32 m0, s66
    s_barrier
    buffer_load_dwordx4 v191, s[36:39], s67 offen offset:0 sc1 lds
    s_add_u32 m0, s66, 16
    s_nop 0
    buffer_load_dwordx4 v191, s[36:39], s67 offen offset:1024 sc1 lds
    s_add_u32 m0, s66, 32
    s_nop 0
    buffer_load_dwordx4 v191, s[36:39], s67 offen offset:2048 sc1 lds
    s_add_u32 m0, s66, 48
    s_nop 0
    buffer_load_dwordx4 v191, s[36:39], s67 offen offset:3072 sc1 lds
    s_mov_b32 s24, s4
    s_mov_b32 s25, s5
    s_mov_b32 s26, 3200000
    s_mov_b32 s27, 0x20000
    s_and_b32 s3, s2, 7
    s_lshl_b32 s3, s3, 5
    s_lshr_b32 s77, s2, 3
    s_add_u32 s3, s3, s77
    s_mul_i32 s77, s3, 200000
    s_lshr_b32 s77, s77, 11
    s_sub_u32 s77, s77, 1
    s_max_i32 s77, s77, 0
    v_lshrrev_b32 v22, 4, v1
    v_and_b32 v23, 7, v1
    v_xor_b32 v22, v22, v23
    v_lshlrev_b32 v238, 4, v22
    v_xor_b32 v239, 64, v238
    v_lshrrev_b32 v22, 3, v1
    v_lshl_or_b32 v21, v22, 7, v239
    v_lshl_or_b32 v20, v22, 7, v238
    v_bfe_u32 v4, v1, 2, 2
    v_lshrrev_b32 v5, 5, v1
    v_lshl_or_b32 v4, v5, 3, v4
    v_lshlrev_b32 v4, 7, v4
    v_and_b32 v5, 3, v1
    v_lshl_or_b32 v4, v5, 3, v4
    v_bfe_u32 v5, v1, 4, 1
    v_lshl_or_b32 v4, v5, 5, v4
    s_and_b32 s3, s52, 3
    s_lshl_b32 s3, s3, 11
    s_lshr_b32 s66, s52, 2
    s_lshl_b32 s66, s66, 6
    s_add_u32 s3, s3, s66
    s_add_u32 s3, s3, 84992
    v_add_u32 v5, s3, v4
    s_and_b32 s3, s52, 1
    s_lshl_b32 s66, s3, 6
    s_add_u32 s66, s66, 101376
    v_add_u32 v4, s66, v4
    v_bfe_u32 v6, v1, 1, 4
    v_lshrrev_b32 v7, 5, v1
    v_lshl_or_b32 v6, v7, 5, v6
    v_lshlrev_b32 v6, 4, v6
    v_and_b32 v8, 1, v1
    s_lshl_b32 s3, s3, 8
    v_lshl_or_b32 v7, v8, 10, v6
    v_add_u32 v7, s3, v7
    v_lshl_or_b32 v6, v8, 12, v6
    s_and_b32 s3, s52, 3
    s_lshl_b32 s3, s3, 10
    s_lshr_b32 s66, s52, 2
    s_lshl_b32 s66, s66, 8
    s_add_u32 s3, s3, s66
    v_add_u32 v6, s3, v6
    s_cmp_lt_u32 s52, 6
    s_cbranch_scc0 P_sy1
    s_waitcnt vmcnt(4)
P_sy1:
    s_waitcnt vmcnt(5)
    s_barrier
    ds_read_b64_tr_b16 v[100:101], v5 offset:8192
    ds_read_b64_tr_b16 v[102:103], v5 offset:8704
    ds_read_b64_tr_b16 v[104:105], v4 offset:0
    ds_read_b64_tr_b16 v[106:107], v4 offset:512
    ds_read_b64_tr_b16 v[108:109], v5 offset:18432
    ds_read_b64_tr_b16 v[110:111], v5 offset:18944
    ds_read_b64_tr_b16 v[112:113], v5 offset:0
    ds_read_b64_tr_b16 v[114:115], v5 offset:512
    ds_read_b64_tr_b16 v[116:117], v5 offset:26624
    ds_read_b64_tr_b16 v[118:119], v5 offset:27136
    s_mov_b32 s3, 0xbfb8aa3b
    s_mov_b32 s66, 0xffff0000
    s_waitcnt lgkmcnt(6)
    v_lshlrev_b32 v8, 16, v100
    v_and_b32 v100, s66, v100
    v_mul_f32 v8, s3, v8
    v_mul_f32 v100, s3, v100
    v_cvt_pk_bf16_f32 v100, v8, v100
    v_lshlrev_b32 v8, 16, v101
    v_and_b32 v101, s66, v101
    v_mul_f32 v8, s3, v8
    v_mul_f32 v101, s3, v101
    v_cvt_pk_bf16_f32 v101, v8, v101
    v_lshlrev_b32 v8, 16, v102
    v_and_b32 v102, s66, v102
    v_mul_f32 v8, s3, v8
    v_mul_f32 v102, s3, v102
    v_cvt_pk_bf16_f32 v102, v8, v102
    v_lshlrev_b32 v8, 16, v103
    v_and_b32 v103, s66, v103
    v_mul_f32 v8, s3, v8
    v_mul_f32 v103, s3, v103
    v_cvt_pk_bf16_f32 v103, v8, v103
    v_lshlrev_b32 v8, 16, v104
    v_and_b32 v104, s66, v104
    v_mul_f32 v8, s3, v8
    v_mul_f32 v104, s3, v104
    v_cvt_pk_bf16_f32 v104, v8, v104
    v_lshlrev_b32 v8, 16, v105
    v_and_b32 v105, s66, v105
    v_mul_f32 v8, s3, v8
    v_mul_f32 v105, s3, v105
    v_cvt_pk_bf16_f32 v105, v8, v105
    v_lshlrev_b32 v8, 16, v106
    v_and_b32 v106, s66, v106
    v_mul_f32 v8, s3, v8
    v_mul_f32 v106, s3, v106
    v_cvt_pk_bf16_f32 v106, v8, v106
    v_lshlrev_b32 v8, 16, v107
    v_and_b32 v107, s66, v107
    v_mul_f32 v8, s3, v8
    v_mul_f32 v107, s3, v107
    v_cvt_pk_bf16_f32 v107, v8, v107
    ds_write_b128 v6, v[100:103] offset:16896
    ds_write_b128 v7, v[104:107] offset:33280
    s_waitcnt lgkmcnt(2)
    ds_write_b128 v6, v[108:111] offset:25088
    ds_write_b128 v6, v[112:115] offset:35328
    ds_write_b128 v6, v[116:119] offset:43520
    s_lshr_b32 s3, s2, 3
    s_mul_i32 s3, s3, 100096
    v_lshlrev_b32 v4, 7, v0
    s_cmp_lt_u32 s52, 8
    s_cselect_b32 s3, 0x40000000, s3
    v_lshrrev_b32 v5, 7, v0
    v_mul_u32_u24 v5, 1040, v5
    v_bfe_u32 v6, v0, 5, 2
    v_lshl_add_u32 v5, v6, 7, v5
    v_and_b32 v7, 31, v0
    v_lshl_add_u32 v6, v7, 2, v5
    v_add_u32 v7, -2, v7
    v_lshrrev_b32 v8, 5, v0
    v_mul_u32_u24 v8, s60, v8
    s_mov_b32 s66, 1638400
    s_waitcnt vmcnt(0) lgkmcnt(0)
    s_barrier
    ds_read_b32 v12, v6 offset:51712
    ds_read_u8 v13, v5 offset:51719
    ds_read_b64 v[84:85], v224 offset:0
    ds_read_b64 v[86:87], v224 offset:128
    ds_read_b64 v[88:89], v224 offset:256
    ds_read_b64 v[90:91], v224 offset:384
    s_waitcnt lgkmcnt(4)
    v_alignbit_b32 v14, v12, v12, 18
    v_and_b32 v14, s59, v14
    v_add_u32 v14, v14, v8
    v_and_b32 v12, s57, v12
    v_cmpx_lt_u32 vcc, v7, v13
    buffer_load_dword v254, v14, s[28:31], 0 offen
    s_mov_b64 exec, -1
    s_waitcnt lgkmcnt(3)
    v_perm_b32 v232, v85, v84, s74
    s_waitcnt lgkmcnt(2)
    v_perm_b32 v233, v87, v86, s74
    s_waitcnt lgkmcnt(1)
    v_perm_b32 v234, v89, v88, s74
    s_waitcnt lgkmcnt(0)
    v_perm_b32 v235, v91, v90, s74
    v_max3_u32 v220, v232, v233, v234
    v_max_u32 v220, v220, v235
    v_cmp_le_u32 vcc, 2031616, v220
    s_cmp_lg_u64 vcc, 0
    s_cbranch_scc1 M_setovf
M_build:
    v_sub_u32_sdwa v212, v232, v232 dst_sel:DWORD dst_unused:UNUSED_PAD src0_sel:WORD_1 src1_sel:WORD_0
    v_sub_u32_sdwa v213, v233, v233 dst_sel:DWORD dst_unused:UNUSED_PAD src0_sel:WORD_1 src1_sel:WORD_0
    v_sub_u32_sdwa v214, v234, v234 dst_sel:DWORD dst_unused:UNUSED_PAD src0_sel:WORD_1 src1_sel:WORD_0
    v_sub_u32_sdwa v215, v235, v235 dst_sel:DWORD dst_unused:UNUSED_PAD src0_sel:WORD_1 src1_sel:WORD_0
    v_add3_u32 v220, v212, v213, v214
    v_add_u32 v221, v220, v215
    v_add_u32 v220, v220, v215
    v_mad_u32_u16 v224, v232, 1, v204
    v_add_u32_dpp v221, v221, v221 row_shr:1 row_mask:0xf bank_mask:0xf bound_ctrl:0
    v_mad_u32_u16 v225, v233, 1, v205
    v_mad_u32_u16 v226, v234, 1, v206
    v_add_u32_dpp v221, v221, v221 row_shr:2 row_mask:0xf bank_mask:0xf bound_ctrl:0
    v_mad_u32_u16 v227, v235, 1, v207
    v_add_u32 v218, v213, v212
    v_add_u32_dpp v221, v221, v221 row_shr:4 row_mask:0xf bank_mask:0xf bound_ctrl:0
    v_add_u32 v219, v214, v218
    v_sub_u32 v225, v225, v212
    v_add_u32_dpp v221, v221, v221 row_shr:8 row_mask:0xf bank_mask:0xf bound_ctrl:0
    v_sub_u32 v226, v226, v218
    v_sub_u32 v227, v227, v219
    v_add_u32_dpp v221, v221, v221 row_bcast:15 row_mask:0xa bank_mask:0xf
    s_nop 1
    v_add_u32_dpp v221, v221, v221 row_bcast:31 row_mask:0xc bank_mask:0xf
    v_sub_u32 v222, v221, v220
    v_readlane_b32 s63, v221, 63
    v_lshl_add_u32 v216, v222, 2, s54
    v_lshl_add_u32 v217, v212, 2, v216
    s_cmp_lt_u32 s63, 512
    s_cbranch_scc0 M_nofit
M_fit:
    s_lshl_b32 s3, s63, 2
    s_add_u32 s3, s3, s54
    v_mov_b32 v220, s3
    v_mov_b32 v221, s75
    ds_write_b32 v220, v221
    s_lshl_b32 s3, s63, 3
    s_or_b32 s3, s3, s52
    s_or_b32 s66, s61, s64
    s_lshl_b32 s66, s66, 31
    s_or_b32 s3, s3, s66
    v_mov_b32 v223, s3
    ds_write_b32 v59, v223 offset:448
    v_sub_u32 v224, v224, v222
    v_cmpx_lt_u32 vcc, 0, v212
    ds_write_b32 v216, v224
    s_mov_b64 exec, -1
    v_sub_u32 v225, v225, v222
    v_cmpx_lt_u32 vcc, 0, v213
    ds_write_b32 v217, v225
    s_mov_b64 exec, -1
    v_sub_u32 v226, v226, v222
    v_lshl_add_u32 v218, v218, 2, v216
    v_cmpx_lt_u32 vcc, 0, v214
    ds_write_b32 v218, v226
    s_mov_b64 exec, -1
    v_sub_u32 v227, v227, v222
    v_lshl_add_u32 v219, v219, 2, v216
    v_cmpx_lt_u32 vcc, 0, v215
    ds_write_b32 v219, v227
    s_mov_b64 exec, -1
    ds_read_b128 v[36:39], v53
    ds_read_b128 v[40:43], v53 offset:16
    s_cmp_eq_u32 s62, 0
    s_waitcnt lgkmcnt(0)
    s_cbranch_scc1 M_nokb
    s_barrier
M_nokb:
    ds_read_b32 v54, v56 offset:448
    ds_read_b32 v55, v57 offset:448
    v_max3_u32 v220, v36, v37, v38
    v_max3_u32 v221, v39, v40, v41
    v_max3_u32 v220, v220, v42, v43
    v_max_u32 v220, v220, v221
    v_max_u32 v37, v36, v37
    v_max_u32 v38, v37, v38
    v_max_u32_dpp v220, v220, v220 row_shr:1 row_mask:0xf bank_mask:0xf bound_ctrl:0
    v_max_u32 v39, v38, v39
    v_max_u32 v40, v39, v40
    v_max_u32_dpp v220, v220, v220 row_shr:2 row_mask:0xf bank_mask:0xf bound_ctrl:0
    v_max_u32 v41, v40, v41
    v_max_u32 v42, v41, v42
    v_max_u32_dpp v220, v220, v220 row_shr:4 row_mask:0xf bank_mask:0xf bound_ctrl:0
    v_max_u32 v43, v42, v43
    s_nop 0
    v_max_u32_dpp v220, v220, v220 row_shr:8 row_mask:0xf bank_mask:0xf bound_ctrl:0
    s_nop 1
    v_max_u32_dpp v220, v220, v220 row_bcast:15 row_mask:0xa bank_mask:0xf
    s_nop 1
    v_max_u32_dpp v220, v220, v220 row_bcast:31 row_mask:0xc bank_mask:0xf
    s_nop 1
    v_mov_b32_dpp v221, v220 wave_shr:1 row_mask:0xf bank_mask:0xf bound_ctrl:0
    v_max_u32 v36, v221, v36
    v_mad_u32_u16 v44, v36, 4, v52
    v_max_u32 v37, v221, v37
    v_mad_u32_u16 v45, v37, 4, v52
    v_max_u32 v38, v221, v38
    v_mad_u32_u16 v46, v38, 4, v52
    v_max_u32 v39, v221, v39
    v_mad_u32_u16 v47, v39, 4, v52
    v_max_u32 v40, v221, v40
    v_mad_u32_u16 v48, v40, 4, v52
    v_max_u32 v41, v221, v41
    v_mad_u32_u16 v49, v41, 4, v52
    v_max_u32 v42, v221, v42
    v_mad_u32_u16 v50, v42, 4, v52
    v_max_u32 v43, v221, v43
    v_mad_u32_u16 v51, v43, 4, v52
    s_cbranch_scc1 M_ggather
    ds_read_b32 v44, v44 offset:0
    ds_read_b32 v45, v45 offset:4
    ds_read_b32 v46, v46 offset:8
    ds_read_b32 v47, v47 offset:12
    ds_read_b32 v48, v48 offset:16
    ds_read_b32 v49, v49 offset:20
    ds_read_b32 v50, v50 offset:24
    ds_read_b32 v51, v51 offset:28
    s_waitcnt lgkmcnt(8)
    v_cmp_gt_u32 vcc, v55, v54
    v_cmp_gt_i32 s[66:67], 0, v55
    s_lshl_b32 s3, s52, 3
    v_lshrrev_b64 v[222:223], v243, vcc
    v_and_b32 v222, 0xff, v222
    v_bcnt_u32_b32 v222, v222, 0
    v_cmp_eq_u32 vcc, s76, v222
    s_ff1_i32_b64 s68, vcc
    s_cmp_lg_u64 s[66:67], 0
    s_cselect_b32 s44, s3, s68
    s_cselect_b32 s46, 1, 0
    v_readlane_b32 s45, v54, s44
    s_cmp_eq_u32 s62, 0
M_gathered:
    s_mov_b32 s3, 0x0c0c0602
    s_mov_b32 s66, 0x05040100
    v_perm_b32 v220, v37, v36, s3
    v_perm_b32 v221, v39, v38, s3
    v_perm_b32 v222, v41, v40, s3
    v_perm_b32 v223, v43, v42, s3
    v_perm_b32 v220, v221, v220, s66
    v_perm_b32 v221, v223, v222, s66
    ds_write_b64 v58, v[220:221]
    s_waitcnt lgkmcnt(1)
    ds_write_b128 v53, v[44:47]
    ds_write_b128 v53, v[48:51] offset:16
    s_cbranch_scc1 M_pad
    s_cmp_lg_u32 s46, 0
    s_cbranch_scc1 M_special
M_key:
    s_bfe_u32 s63, s45, 0x100003
    s_lshr_b32 s3, s44, 3
    s_and_b32 s53, s53, 0x7f8
    s_add_u32 s53, s53, s3
    s_mul_i32 s54, s3, 3520
    s_add_u32 s54, s54, 134144
    s_add_u32 s73, s54, 2816
    s_mul_i32 s77, s53, 25000
    s_lshr_b32 s77, s77, 11
    s_sub_u32 s77, s77, 1
    s_max_i32 s77, s77, 0
    s_lshl_b32 s46, s52, 11
    s_add_u32 s46, s46, 512
    s_mov_b32 m0, s46
    s_lshl_b32 s3, s77, 7
    buffer_load_dwordx4 v20, s[24:27], s3 offen lds
    buffer_load_dwordx4 v21, s[24:27], s3 offen offset:1024 lds
    v_add_u32 v243, s54, v243
    v_add_u32 v244, s54, v244
    v_add_u32 v245, s73, v245
    v_add_u32 v246, s54, v246
    v_mov_b32 v225, v191
    s_waitcnt lgkmcnt(0)
    s_barrier
    ds_read2_b64 v[220:223], v243 offset0:0 offset1:8
    ds_read_b32 v236, v244 offset:0
    ds_read_u8 v237, v245 offset:0
    ds_read_b128 v[100:103], v225 offset:35328
    ds_read_b128 v[104:107], v225 offset:36352
    ds_read_b128 v[108:111], v225 offset:37376
    ds_read_b128 v[112:115], v225 offset:38400
    ds_read_b128 v[116:119], v225 offset:39424
    ds_read_b128 v[120:123], v225 offset:40448
    ds_read_b128 v[124:127], v225 offset:41472
    ds_read_b128 v[128:131], v225 offset:42496
    s_waitcnt lgkmcnt(8)
    s_add_u32 m0, s55, 0
    v_and_or_b32 v220, v220, s57, v238
    buffer_load_dwordx4 v220, s[24:27], 0 offen  lds
    s_add_u32 m0, s55, 1024
    v_and_or_b32 v221, v221, s57, v239
    buffer_load_dwordx4 v221, s[24:27], 0 offen  lds
    s_add_u32 m0, s55, 2048
    v_and_or_b32 v222, v222, s57, v238
    buffer_load_dwordx4 v222, s[24:27], 0 offen  lds
    s_add_u32 m0, s55, 3072
    v_and_or_b32 v223, v223, s57, v239
    buffer_load_dwordx4 v223, s[24:27], 0 offen  lds
    v_alignbit_b32 v236, v236, v236, 18
    v_and_or_b32 v236, v236, s59, v241
    v_mad_u32_u24 v236, v237, s60, v236
    buffer_load_dwordx4 v[196:199], v236, s[28:31], 0 offen
    ds_read2_b64 v[220:223], v243 offset0:16 offset1:24
    ds_read_b32 v236, v244 offset:128
    ds_read_u8 v237, v245 offset:32
    s_add_u32 s3, s63, 31
    s_lshr_b32 s3, s3, 5
    s_mul_i32 s3, s3, s78
    v_mov_b32 v227, s3
    s_mov_b64 exec, 1
    ds_sub_u32 v250, v227
    s_mov_b64 exec, -1
    s_mul_i32 s3, s53, 25000
    s_lshr_b32 s3, s3, 11
    s_sub_u32 s3, s3, 1
    s_mov_b32 s68, 85899
    v_subrev_u32 v226, s3, v2
    v_and_b32 v226, 15, v226
    v_add_u32 v226, s3, v226
    v_subrev_u32 v20, s77, v226
    v_min_u32 v20, 15, v20
    v_lshlrev_b32 v21, 3, v20
    v_and_b32 v21, 0x70, v21
    v_xor_b32 v21, v21, v241
    v_lshl_or_b32 v20, v20, 7, v21
    v_add_u32 v20, s46, v20
    v_xor_b32 v21, 32, v20
    v_xor_b32 v22, 64, v20
    v_xor_b32 v23, 0x60, v20
    ds_read_b128 v[132:135], v225 offset:43520
    ds_read_b128 v[136:139], v225 offset:44544
    ds_read_b128 v[140:143], v225 offset:45568
    ds_read_b128 v[144:147], v225 offset:46592
    ds_read_b128 v[148:151], v225 offset:47616
    ds_read_b128 v[152:155], v225 offset:48640
    ds_read_b128 v[156:159], v225 offset:49664
    ds_read_b128 v[160:163], v225 offset:50688
    v_add_u32 v226, s3, v1
    v_mul_u32_u24 v227, s68, v226
    v_lshrrev_b32 v227, 20, v227
    v_cmp_eq_u32 vcc, s53, v227
    s_movk_i32 s68, 25000
    v_cmp_gt_u32 s[66:67], s68, v226
    v_lshlrev_b32 v2, 6, v241
    s_and_b32 s66, vcc_lo, s66
    s_ff1_i32_b32 s67, s66
    s_bcnt1_i32_b32 s66, s66
    s_add_u32 s3, s3, s67
    s_lshl_b32 s3, s3, 7
    s_add_u32 s40, s18, s3
    s_addc_u32 s41, s19, 0
    s_lshl_b32 s42, s66, 7
    s_mov_b32 s43, 0x20000
    v_subrev_u32 v2, s3, v2
    s_waitcnt vmcnt(5)
    ds_read_b128 v[180:183], v20
    ds_read_b128 v[184:187], v21
    ds_read_b128 v[188:191], v22
    ds_read_b128 v[192:195], v23
    s_waitcnt lgkmcnt(0)
    v_mfma_f32_32x32x16_bf16 v[36:51], v[180:183], v[100:103], 0
    v_mfma_f32_32x32x16_bf16 v[36:51], v[184:187], v[104:107], v[36:51]
    v_mfma_f32_32x32x16_bf16 v[36:51], v[188:191], v[108:111], v[36:51]
    v_mfma_f32_32x32x16_bf16 v[36:51], v[192:195], v[112:115], v[36:51]
    v_mfma_f32_32x32x16_bf16 v[52:67], v[180:183], v[116:119], 0
    v_mfma_f32_32x32x16_bf16 v[52:67], v[184:187], v[120:123], v[52:67]
    v_mfma_f32_32x32x16_bf16 v[52:67], v[188:191], v[124:127], v[52:67]
    v_mfma_f32_32x32x16_bf16 v[52:67], v[192:195], v[128:131], v[52:67]
    s_waitcnt lgkmcnt(0)
    ds_read_b128 v[100:103], v225 offset:16896
    ds_read_b128 v[104:107], v225 offset:17920
    ds_read_b128 v[108:111], v225 offset:18944
    ds_read_b128 v[112:115], v225 offset:19968
    ds_read_b128 v[116:119], v225 offset:20992
    ds_read_b128 v[120:123], v225 offset:22016
    ds_read_b128 v[124:127], v225 offset:23040
    ds_read_b128 v[128:131], v225 offset:24064
    v_mfma_f32_32x32x16_bf16 v[68:83], v[180:183], v[132:135], 0
    v_mfma_f32_32x32x16_bf16 v[68:83], v[184:187], v[136:139], v[68:83]
    v_mfma_f32_32x32x16_bf16 v[68:83], v[188:191], v[140:143], v[68:83]
    v_mfma_f32_32x32x16_bf16 v[68:83], v[192:195], v[144:147], v[68:83]
    v_mfma_f32_32x32x16_bf16 v[84:99], v[180:183], v[148:151], 0
    v_mfma_f32_32x32x16_bf16 v[84:99], v[184:187], v[152:155], v[84:99]
    v_mfma_f32_32x32x16_bf16 v[84:99], v[188:191], v[156:159], v[84:99]
    v_mfma_f32_32x32x16_bf16 v[84:99], v[192:195], v[160:163], v[84:99]
    ds_read_b128 v[132:135], v225 offset:25088
    ds_read_b128 v[136:139], v225 offset:26112
    ds_read_b128 v[140:143], v225 offset:27136
    ds_read_b128 v[144:147], v225 offset:28160
    ds_read_b128 v[148:151], v225 offset:29184
    ds_read_b128 v[152:155], v225 offset:30208
    ds_read_b128 v[156:159], v225 offset:31232
    ds_read_b128 v[160:163], v225 offset:32256
    ds_read_b128 v[164:167], v225 offset:33280
    ds_read_b128 v[168:171], v225 offset:34304
    s_mov_b32 s3, 0xbfb8aa3b
    v_mul_f32 v36, s3, v36
    v_mul_f32 v37, s3, v37
    v_mul_f32 v38, s3, v38
    v_mul_f32 v39, s3, v39
    v_mul_f32 v40, s3, v40
    v_mul_f32 v41, s3, v41
    v_mul_f32 v42, s3, v42
    v_mul_f32 v43, s3, v43
    v_cvt_pk_bf16_f32 v172, v36, v37
    v_cvt_pk_bf16_f32 v173, v38, v39
    v_cvt_pk_bf16_f32 v174, v40, v41
    v_cvt_pk_bf16_f32 v175, v42, v43
    v_mul_f32 v52, s3, v52
    v_mul_f32 v53, s3, v53
    v_mul_f32 v54, s3, v54
    v_mul_f32 v55, s3, v55
    v_mul_f32 v56, s3, v56
    v_mul_f32 v57, s3, v57
    v_mul_f32 v58, s3, v58
    v_mul_f32 v59, s3, v59
    v_cvt_pk_bf16_f32 v176, v52, v53
    v_cvt_pk_bf16_f32 v177, v54, v55
    v_cvt_pk_bf16_f32 v178, v56, v57
    v_cvt_pk_bf16_f32 v179, v58, v59
    v_mov_b32 v76, 0
    v_mov_b32 v77, 0
    v_mov_b32 v78, 0
    v_mov_b32 v79, 0
    v_mov_b32 v80, 0
    v_mov_b32 v81, 0
    v_mov_b32 v82, 0
    v_mov_b32 v83, 0
    v_mov_b32 v92, 0
    v_mov_b32 v93, 0
    v_mov_b32 v94, 0
    v_mov_b32 v95, 0
    v_mov_b32 v96, 0
    v_mov_b32 v97, 0
    v_mov_b32 v98, 0
    v_mov_b32 v99, 0
    s_mov_b32 s62, 0
    s_add_u32 m0, s55, 4096
    v_and_or_b32 v220, v220, s57, v238
    buffer_load_dwordx4 v220, s[24:27], 0 offen  lds
    s_add_u32 m0, s55, 5120
    v_and_or_b32 v221, v221, s57, v239
    buffer_load_dwordx4 v221, s[24:27], 0 offen  lds
    s_add_u32 m0, s55, 6144
    v_and_or_b32 v222, v222, s57, v238
    buffer_load_dwordx4 v222, s[24:27], 0 offen  lds
    s_add_u32 m0, s55, 7168
    v_and_or_b32 v223, v223, s57, v239
    buffer_load_dwordx4 v223, s[24:27], 0 offen  lds
    v_alignbit_b32 v236, v236, v236, 18
    v_and_or_b32 v236, v236, s59, v241
    v_mad_u32_u24 v236, v237, s60, v236
    buffer_load_dwordx4 v[200:203], v236, s[28:31], 0 offen
M_pf2:
    ds_read_b32 v3, v244
    ds_read2_b64 v[220:223], v243 offset0:32 offset1:40
    s_add_u32 s56, s63, 31
    s_lshr_b32 s56, s56, 5
    s_waitcnt lgkmcnt(0)
    s_sub_u32 s56, s56, 1
    s_cbranch_scc1 M_after0
    v_bitop3_b32 v3, v3, s58, v242 bitop3:0x6a
    ds_read2_b64 v[204:207], v3 offset0:16 offset1:12
    v_mov_b32 v212, 0
    v_mov_b32 v213, 0
    v_mov_b32 v214, 0
    v_mov_b32 v215, 0
    v_mov_b32 v216, 0
    v_mov_b32 v217, 0
    v_mov_b32 v218, 0
    v_mov_b32 v219, 0
    v_mov_b32 v208, 0
    v_mov_b32 v209, 0
    v_mov_b32 v210, 0
    v_mov_b32 v211, 0
    s_waitcnt vmcnt(6)
    ds_read_b128 v[180:183], v228 offset:0
    ds_read_b128 v[184:187], v229 offset:0
    ds_read_b128 v[188:191], v230 offset:0
    ds_read_b128 v[192:195], v231 offset:0
    s_waitcnt lgkmcnt(0)
    v_mfma_f32_32x32x16_bf16 v[4:19], v[204:207], v[172:175], 0
    ds_read2_b32 v[224:225], v246 offset0:0 offset1:8
    ds_read_b32 v3, v244 offset:128
    v_mfma_f32_32x32x16_bf16 v[4:19], v[180:183], v[100:103], v[4:19]
    v_mfma_f32_32x32x16_bf16 v[36:51], v[180:183], v[132:135], 0
    v_mfma_f32_32x32x16_bf16 v[4:19], v[184:187], v[104:107], v[4:19]
    v_mfma_f32_32x32x16_bf16 v[36:51], v[184:187], v[136:139], v[36:51]
    v_mfma_f32_32x32x16_bf16 v[4:19], v[188:191], v[108:111], v[4:19]
    v_mfma_f32_32x32x16_bf16 v[4:19], v[192:195], v[112:115], v[4:19]
    s_add_u32 m0, s55, 0
    v_and_or_b32 v220, v220, s57, v238
    buffer_load_dwordx4 v220, s[24:27], 0 offen  lds
    s_add_u32 m0, s55, 1024
    v_and_or_b32 v221, v221, s57, v239
    buffer_load_dwordx4 v221, s[24:27], 0 offen  lds
    s_waitcnt vmcnt(7)
    v_mfma_f32_32x32x16_bf16 v[4:19], v[196:199], v[164:167], v[4:19]
    s_add_u32 m0, s55, 2048
    v_and_or_b32 v222, v222, s57, v238
    buffer_load_dwordx4 v222, s[24:27], 0 offen  lds
    s_add_u32 m0, s55, 3072
    v_and_or_b32 v223, v223, s57, v239
    buffer_load_dwordx4 v223, s[24:27], 0 offen  lds
    v_mfma_f32_32x32x16_bf16 v[36:51], v[188:191], v[140:143], v[36:51]
    ds_read_b32 v236, v244 offset:256
    ds_read_u8 v237, v245 offset:64
    s_waitcnt lgkmcnt(3)
    v_bitop3_b32 v224, v224, s58, v240 bitop3:0x6a
    v_bitop3_b32 v225, v225, s58, v240 bitop3:0x6a
    v_mfma_f32_32x32x16_bf16 v[36:51], v[192:195], v[144:147], v[36:51]
    s_waitcnt lgkmcnt(2)
    v_bitop3_b32 v3, v3, s58, v242 bitop3:0x6a
    s_waitcnt lgkmcnt(0)
    s_nop 7
    s_cmp_eq_u32 s56, 0
    s_cbranch_scc1 M_tail0
    s_cmp_ge_u32 s52, 4
    s_cbranch_scc1 HM_s01
    s_setprio 2
    s_branch M_s01
.p2align 6
M_s00:
    s_setprio 2
    v_exp_f32 v20, v20
    v_exp_f32 v21, v21
    v_smfmac_f32_32x32x32_bf16 v[68:83], v[208:211], v[212:219], v248
    ds_read2_b32 v[224:225], v246 offset0:0 offset1:8
    ds_read_b32 v3, v244 offset:128
    v_exp_f32 v22, v22
    v_exp_f32 v23, v23
    v_exp_f32 v24, v24
    v_exp_f32 v25, v25
    v_mfma_f32_32x32x16_bf16 v[4:19], v[204:207], v[172:175], 0
    v_exp_f32 v26, v26
    v_exp_f32 v27, v27
    v_exp_f32 v28, v28
    v_exp_f32 v29, v29
    v_mfma_f32_32x32x16_bf16 v[4:19], v[180:183], v[100:103], v[4:19]
    v_and_or_b32 v220, v220, s57, v238
    v_and_or_b32 v221, v221, s57, v239
    v_exp_f32 v30, v30
    v_exp_f32 v31, v31
    v_mfma_f32_32x32x16_bf16 v[36:51], v[180:183], v[132:135], 0
    v_and_or_b32 v222, v222, s57, v238
    v_and_or_b32 v223, v223, s57, v239
    v_exp_f32 v32, v32
    v_exp_f32 v33, v33
    v_exp_f32 v34, v34
    v_mfma_f32_32x32x16_bf16 v[4:19], v[184:187], v[104:107], v[4:19]
    v_exp_f32 v35, v35
    s_setprio 0
    s_waitcnt lgkmcnt(2)
    s_add_u32 m0, s55, 0
    s_nop 0
    buffer_load_dwordx4 v220, s[24:27], 0 offen  lds
    s_add_u32 m0, s55, 1024
    s_nop 0
    buffer_load_dwordx4 v221, s[24:27], 0 offen  lds
    v_add_f32 v20, 1.0, v20
    v_add_f32 v21, 1.0, v21
    v_add_f32 v22, 1.0, v22
    v_add_f32 v23, 1.0, v23
    v_add_f32 v24, 1.0, v24
    v_add_f32 v25, 1.0, v25
    v_add_f32 v26, 1.0, v26
    v_add_f32 v27, 1.0, v27
    v_add_f32 v28, 1.0, v28
    v_add_f32 v29, 1.0, v29
    v_add_f32 v30, 1.0, v30
    v_add_f32 v31, 1.0, v31
    v_add_f32 v32, 1.0, v32
    v_add_f32 v33, 1.0, v33
    v_add_f32 v34, 1.0, v34
    v_add_f32 v35, 1.0, v35
    s_setprio 2
    v_rcp_f32 v20, v20
    v_rcp_f32 v21, v21
    v_mfma_f32_32x32x16_bf16 v[36:51], v[184:187], v[136:139], v[36:51]
    v_rcp_f32 v22, v22
    v_rcp_f32 v23, v23
    v_rcp_f32 v24, v24
    v_rcp_f32 v25, v25
    v_mfma_f32_32x32x16_bf16 v[4:19], v[188:191], v[108:111], v[4:19]
    v_rcp_f32 v26, v26
    v_rcp_f32 v27, v27
    v_rcp_f32 v28, v28
    v_rcp_f32 v29, v29
    v_mfma_f32_32x32x16_bf16 v[4:19], v[192:195], v[112:115], v[4:19]
    v_rcp_f32 v30, v30
    v_rcp_f32 v31, v31
    v_rcp_f32 v32, v32
    s_waitcnt vmcnt(7)
    v_mfma_f32_32x32x16_bf16 v[4:19], v[196:199], v[164:167], v[4:19]
    v_rcp_f32 v33, v33
    v_rcp_f32 v34, v34
    v_rcp_f32 v35, v35
    s_setprio 0
    s_add_u32 m0, s55, 2048
    s_nop 0
    buffer_load_dwordx4 v222, s[24:27], 0 offen  lds
    s_add_u32 m0, s55, 3072
    s_nop 0
    buffer_load_dwordx4 v223, s[24:27], 0 offen  lds
    v_mul_f32 v20, v20, v52
    v_mul_f32 v21, v21, v53
    v_mul_f32 v22, v22, v54
    v_mul_f32 v23, v23, v55
    v_mul_f32 v24, v24, v56
    v_mul_f32 v25, v25, v57
    v_mul_f32 v26, v26, v58
    v_mul_f32 v27, v27, v59
    v_mul_f32 v28, v28, v60
    v_mul_f32 v29, v29, v61
    v_mul_f32 v30, v30, v62
    v_mul_f32 v31, v31, v63
    v_mul_f32 v32, v32, v64
    v_mul_f32 v33, v33, v65
    v_mul_f32 v34, v34, v66
    v_mul_f32 v35, v35, v67
    s_setprio 2
    v_cvt_pk_bf16_f32 v212, v20, v21
    v_mfma_f32_32x32x16_bf16 v[36:51], v[188:191], v[140:143], v[36:51]
    ds_read_b32 v236, v244 offset:256
    ds_read_u8 v237, v245 offset:64
    s_waitcnt lgkmcnt(3)
    v_bitop3_b32 v224, v224, s58, v240 bitop3:0x6a
    v_bitop3_b32 v225, v225, s58, v240 bitop3:0x6a
    v_cvt_pk_bf16_f32 v213, v22, v23
    v_cvt_pk_bf16_f32 v214, v24, v25
    v_cvt_pk_bf16_f32 v215, v26, v27
    v_cvt_pk_bf16_f32 v216, v28, v29
    v_cvt_pk_bf16_f32 v217, v30, v31
    v_mfma_f32_32x32x16_bf16 v[36:51], v[192:195], v[144:147], v[36:51]
    s_waitcnt lgkmcnt(2)
    v_bitop3_b32 v3, v3, s58, v242 bitop3:0x6a
    v_cvt_pk_bf16_f32 v218, v32, v33
    v_cvt_pk_bf16_f32 v219, v34, v35
    s_cmp_eq_u32 s56, 0
    s_cbranch_scc1 M_tail0
M_s01:
    s_setprio 2
    v_exp_f32 v4, v4
    v_exp_f32 v5, v5
    v_smfmac_f32_32x32x32_bf16 v[84:99], v[208:211], v[212:219], v248
    ds_read_b64_tr_b16 v[208:209], v224 offset:128
    ds_read_b64_tr_b16 v[210:211], v225 offset:128
    v_exp_f32 v6, v6
    v_exp_f32 v7, v7
    v_exp_f32 v8, v8
    v_exp_f32 v9, v9
    v_mfma_f32_32x32x16_bf16 v[20:35], v[196:199], v[168:171], 0
    s_waitcnt lgkmcnt(3)
    v_alignbit_b32 v236, v236, v236, 18
    v_and_or_b32 v236, v236, s59, v241
    s_waitcnt lgkmcnt(2)
    v_mad_u32_u24 v236, v237, s60, v236
    v_exp_f32 v10, v10
    v_exp_f32 v11, v11
    v_mfma_f32_32x32x16_bf16 v[20:35], v[204:207], v[176:179], v[20:35]
    ds_read2_b64 v[204:207], v3 offset0:16 offset1:12
    v_exp_f32 v12, v12
    v_exp_f32 v13, v13
    v_exp_f32 v14, v14
    v_mfma_f32_32x32x16_bf16 v[20:35], v[180:183], v[116:119], v[20:35]
    v_exp_f32 v15, v15
    v_exp_f32 v16, v16
    v_exp_f32 v17, v17
    v_exp_f32 v18, v18
    v_mfma_f32_32x32x16_bf16 v[52:67], v[180:183], v[148:151], 0
    s_waitcnt vmcnt(5)
    ds_read_b128 v[180:183], v228 offset:4096
    v_exp_f32 v19, v19
    s_setprio 0
    buffer_load_dwordx4 v[196:199], v236, s[28:31], 0 offen
    v_add_f32 v4, 1.0, v4
    v_add_f32 v5, 1.0, v5
    v_add_f32 v6, 1.0, v6
    v_add_f32 v7, 1.0, v7
    v_add_f32 v8, 1.0, v8
    v_add_f32 v9, 1.0, v9
    v_add_f32 v10, 1.0, v10
    v_add_f32 v11, 1.0, v11
    v_add_f32 v12, 1.0, v12
    v_add_f32 v13, 1.0, v13
    v_add_f32 v14, 1.0, v14
    v_add_f32 v15, 1.0, v15
    v_add_f32 v16, 1.0, v16
    v_add_f32 v17, 1.0, v17
    v_add_f32 v18, 1.0, v18
    v_add_f32 v19, 1.0, v19
    s_setprio 2
    v_rcp_f32 v4, v4
    v_rcp_f32 v5, v5
    v_mfma_f32_32x32x16_bf16 v[20:35], v[184:187], v[120:123], v[20:35]
    v_rcp_f32 v6, v6
    v_rcp_f32 v7, v7
    v_rcp_f32 v8, v8
    v_mfma_f32_32x32x16_bf16 v[52:67], v[184:187], v[152:155], v[52:67]
    ds_read_b128 v[184:187], v229 offset:4096
    v_rcp_f32 v9, v9
    v_rcp_f32 v10, v10
    v_rcp_f32 v11, v11
    v_rcp_f32 v12, v12
    v_mfma_f32_32x32x16_bf16 v[20:35], v[188:191], v[124:127], v[20:35]
    v_rcp_f32 v13, v13
    v_rcp_f32 v14, v14
    v_rcp_f32 v15, v15
    v_mfma_f32_32x32x16_bf16 v[20:35], v[192:195], v[128:131], v[20:35]
    ds_read2_b64 v[220:223], v243 offset0:48 offset1:56
    s_mov_b64 exec, 1
    ds_add_rtn_u32 v252, v250, v251
    s_mov_b64 exec, -1
    v_rcp_f32 v16, v16
    v_rcp_f32 v17, v17
    v_rcp_f32 v18, v18
    v_rcp_f32 v19, v19
    s_setprio 0
    v_mul_f32 v4, v4, v36
    v_mul_f32 v5, v5, v37
    v_mul_f32 v6, v6, v38
    v_mul_f32 v7, v7, v39
    v_mul_f32 v8, v8, v40
    v_mul_f32 v9, v9, v41
    v_mul_f32 v10, v10, v42
    v_mul_f32 v11, v11, v43
    v_mul_f32 v12, v12, v44
    v_mul_f32 v13, v13, v45
    v_mul_f32 v14, v14, v46
    v_mul_f32 v15, v15, v47
    v_mul_f32 v16, v16, v48
    v_mul_f32 v17, v17, v49
    v_mul_f32 v18, v18, v50
    v_mul_f32 v19, v19, v51
    s_setprio 2
    v_mfma_f32_32x32x16_bf16 v[52:67], v[188:191], v[156:159], v[52:67]
    ds_read_b128 v[188:191], v230 offset:4096
    v_cvt_pk_bf16_f32 v212, v4, v5
    v_cvt_pk_bf16_f32 v213, v6, v7
    v_cvt_pk_bf16_f32 v214, v8, v9
    v_cvt_pk_bf16_f32 v215, v10, v11
    v_cvt_pk_bf16_f32 v216, v12, v13
    v_cvt_pk_bf16_f32 v217, v14, v15
    v_mfma_f32_32x32x16_bf16 v[52:67], v[192:195], v[160:163], v[52:67]
    ds_read_b128 v[192:195], v231 offset:4096
    s_waitcnt lgkmcnt(2)
    v_readfirstlane_b32 s3, v252
    v_cvt_pk_bf16_f32 v218, v16, v17
    v_cvt_pk_bf16_f32 v219, v18, v19
    s_sub_u32 s56, s56, 1
    s_mul_i32 s3, s3, s78
    s_cmp_lt_i32 s3, s79
    s_cbranch_scc1 HM_s10
M_s10:
    s_setprio 2
    v_exp_f32 v20, v20
    v_exp_f32 v21, v21
    v_smfmac_f32_32x32x32_bf16 v[68:83], v[208:211], v[212:219], v248
    ds_read2_b32 v[224:225], v246 offset0:32 offset1:40
    ds_read_b32 v3, v244 offset:256
    v_exp_f32 v22, v22
    v_exp_f32 v23, v23
    v_exp_f32 v24, v24
    v_exp_f32 v25, v25
    v_mfma_f32_32x32x16_bf16 v[4:19], v[204:207], v[172:175], 0
    v_exp_f32 v26, v26
    v_exp_f32 v27, v27
    v_exp_f32 v28, v28
    v_exp_f32 v29, v29
    v_mfma_f32_32x32x16_bf16 v[4:19], v[180:183], v[100:103], v[4:19]
    v_and_or_b32 v220, v220, s57, v238
    v_and_or_b32 v221, v221, s57, v239
    v_exp_f32 v30, v30
    v_exp_f32 v31, v31
    v_mfma_f32_32x32x16_bf16 v[36:51], v[180:183], v[132:135], 0
    v_and_or_b32 v222, v222, s57, v238
    v_and_or_b32 v223, v223, s57, v239
    v_exp_f32 v32, v32
    v_exp_f32 v33, v33
    v_exp_f32 v34, v34
    v_mfma_f32_32x32x16_bf16 v[4:19], v[184:187], v[104:107], v[4:19]
    v_exp_f32 v35, v35
    s_setprio 0
    s_waitcnt lgkmcnt(2)
    s_add_u32 m0, s55, 4096
    s_nop 0
    buffer_load_dwordx4 v220, s[24:27], 0 offen  lds
    s_add_u32 m0, s55, 5120
    s_nop 0
    buffer_load_dwordx4 v221, s[24:27], 0 offen  lds
    v_add_f32 v20, 1.0, v20
    v_add_f32 v21, 1.0, v21
    v_add_f32 v22, 1.0, v22
    v_add_f32 v23, 1.0, v23
    v_add_f32 v24, 1.0, v24
    v_add_f32 v25, 1.0, v25
    v_add_f32 v26, 1.0, v26
    v_add_f32 v27, 1.0, v27
    v_add_f32 v28, 1.0, v28
    v_add_f32 v29, 1.0, v29
    v_add_f32 v30, 1.0, v30
    v_add_f32 v31, 1.0, v31
    v_add_f32 v32, 1.0, v32
    v_add_f32 v33, 1.0, v33
    v_add_f32 v34, 1.0, v34
    v_add_f32 v35, 1.0, v35
    s_setprio 2
    v_rcp_f32 v20, v20
    v_rcp_f32 v21, v21
    v_mfma_f32_32x32x16_bf16 v[36:51], v[184:187], v[136:139], v[36:51]
    v_rcp_f32 v22, v22
    v_rcp_f32 v23, v23
    v_rcp_f32 v24, v24
    v_rcp_f32 v25, v25
    v_mfma_f32_32x32x16_bf16 v[4:19], v[188:191], v[108:111], v[4:19]
    v_rcp_f32 v26, v26
    v_rcp_f32 v27, v27
    v_rcp_f32 v28, v28
    v_rcp_f32 v29, v29
    v_mfma_f32_32x32x16_bf16 v[4:19], v[192:195], v[112:115], v[4:19]
    v_rcp_f32 v30, v30
    v_rcp_f32 v31, v31
    v_rcp_f32 v32, v32
    s_waitcnt vmcnt(7)
    v_mfma_f32_32x32x16_bf16 v[4:19], v[200:203], v[164:167], v[4:19]
    v_rcp_f32 v33, v33
    v_rcp_f32 v34, v34
    v_rcp_f32 v35, v35
    s_setprio 0
    s_add_u32 m0, s55, 6144
    s_nop 0
    buffer_load_dwordx4 v222, s[24:27], 0 offen  lds
    s_add_u32 m0, s55, 7168
    s_nop 0
    buffer_load_dwordx4 v223, s[24:27], 0 offen  lds
    v_mul_f32 v20, v20, v52
    v_mul_f32 v21, v21, v53
    v_mul_f32 v22, v22, v54
    v_mul_f32 v23, v23, v55
    v_mul_f32 v24, v24, v56
    v_mul_f32 v25, v25, v57
    v_mul_f32 v26, v26, v58
    v_mul_f32 v27, v27, v59
    v_mul_f32 v28, v28, v60
    v_mul_f32 v29, v29, v61
    v_mul_f32 v30, v30, v62
    v_mul_f32 v31, v31, v63
    v_mul_f32 v32, v32, v64
    v_mul_f32 v33, v33, v65
    v_mul_f32 v34, v34, v66
    v_mul_f32 v35, v35, v67
    s_setprio 2
    v_cvt_pk_bf16_f32 v212, v20, v21
    v_mfma_f32_32x32x16_bf16 v[36:51], v[188:191], v[140:143], v[36:51]
    ds_read_b32 v236, v244 offset:384
    ds_read_u8 v237, v245 offset:96
    s_waitcnt lgkmcnt(3)
    v_bitop3_b32 v224, v224, s58, v240 bitop3:0x6a
    v_bitop3_b32 v225, v225, s58, v240 bitop3:0x6a
    v_cvt_pk_bf16_f32 v213, v22, v23
    v_cvt_pk_bf16_f32 v214, v24, v25
    v_cvt_pk_bf16_f32 v215, v26, v27
    v_cvt_pk_bf16_f32 v216, v28, v29
    v_cvt_pk_bf16_f32 v217, v30, v31
    v_mfma_f32_32x32x16_bf16 v[36:51], v[192:195], v[144:147], v[36:51]
    s_waitcnt lgkmcnt(2)
    v_bitop3_b32 v3, v3, s58, v242 bitop3:0x6a
    v_cvt_pk_bf16_f32 v218, v32, v33
    v_cvt_pk_bf16_f32 v219, v34, v35
    s_cmp_eq_u32 s56, 0
    s_cbranch_scc1 M_tail1
M_s11:
    s_setprio 2
    v_exp_f32 v4, v4
    v_exp_f32 v5, v5
    v_smfmac_f32_32x32x32_bf16 v[84:99], v[208:211], v[212:219], v248
    ds_read_b64_tr_b16 v[208:209], v224 offset:128
    ds_read_b64_tr_b16 v[210:211], v225 offset:128
    v_exp_f32 v6, v6
    v_exp_f32 v7, v7
    v_exp_f32 v8, v8
    v_exp_f32 v9, v9
    v_mfma_f32_32x32x16_bf16 v[20:35], v[200:203], v[168:171], 0
    s_waitcnt lgkmcnt(3)
    v_alignbit_b32 v236, v236, v236, 18
    v_and_or_b32 v236, v236, s59, v241
    s_waitcnt lgkmcnt(2)
    v_mad_u32_u24 v236, v237, s60, v236
    v_exp_f32 v10, v10
    v_exp_f32 v11, v11
    v_mfma_f32_32x32x16_bf16 v[20:35], v[204:207], v[176:179], v[20:35]
    ds_read2_b64 v[204:207], v3 offset0:16 offset1:12
    v_exp_f32 v12, v12
    v_exp_f32 v13, v13
    v_exp_f32 v14, v14
    v_exp_f32 v15, v15
    v_mfma_f32_32x32x16_bf16 v[20:35], v[180:183], v[116:119], v[20:35]
    v_exp_f32 v16, v16
    v_exp_f32 v17, v17
    v_exp_f32 v18, v18
    v_mfma_f32_32x32x16_bf16 v[52:67], v[180:183], v[148:151], 0
    s_waitcnt vmcnt(5)
    ds_read_b128 v[180:183], v228 offset:0
    v_exp_f32 v19, v19
    s_setprio 0
    buffer_load_dwordx4 v[200:203], v236, s[28:31], 0 offen
    v_add_f32 v4, 1.0, v4
    v_add_f32 v5, 1.0, v5
    v_add_f32 v6, 1.0, v6
    v_add_f32 v7, 1.0, v7
    v_add_f32 v8, 1.0, v8
    v_add_f32 v9, 1.0, v9
    v_add_f32 v10, 1.0, v10
    v_add_f32 v11, 1.0, v11
    v_add_f32 v12, 1.0, v12
    v_add_f32 v13, 1.0, v13
    v_add_f32 v14, 1.0, v14
    v_add_f32 v15, 1.0, v15
    v_add_f32 v16, 1.0, v16
    v_add_f32 v17, 1.0, v17
    v_add_f32 v18, 1.0, v18
    v_add_f32 v19, 1.0, v19
    s_setprio 2
    v_rcp_f32 v4, v4
    v_rcp_f32 v5, v5
    v_rcp_f32 v6, v6
    v_mfma_f32_32x32x16_bf16 v[20:35], v[184:187], v[120:123], v[20:35]
    v_rcp_f32 v7, v7
    v_rcp_f32 v8, v8
    v_rcp_f32 v9, v9
    v_rcp_f32 v10, v10
    v_mfma_f32_32x32x16_bf16 v[52:67], v[184:187], v[152:155], v[52:67]
    ds_read_b128 v[184:187], v229 offset:0
    v_rcp_f32 v11, v11
    v_rcp_f32 v12, v12
    v_rcp_f32 v13, v13
    v_mfma_f32_32x32x16_bf16 v[20:35], v[188:191], v[124:127], v[20:35]
    v_rcp_f32 v14, v14
    v_rcp_f32 v15, v15
    v_rcp_f32 v16, v16
    v_rcp_f32 v17, v17
    v_mfma_f32_32x32x16_bf16 v[20:35], v[192:195], v[128:131], v[20:35]
    ds_read2_b64 v[220:223], v243 offset0:64 offset1:72
    s_mov_b64 exec, 1
    ds_add_rtn_u32 v252, v250, v251
    s_mov_b64 exec, -1
    v_rcp_f32 v18, v18
    v_rcp_f32 v19, v19
    s_setprio 0
    v_mul_f32 v4, v4, v36
    v_mul_f32 v5, v5, v37
    v_mul_f32 v6, v6, v38
    v_mul_f32 v7, v7, v39
    v_mul_f32 v8, v8, v40
    v_mul_f32 v9, v9, v41
    v_mul_f32 v10, v10, v42
    v_mul_f32 v11, v11, v43
    v_mul_f32 v12, v12, v44
    v_mul_f32 v13, v13, v45
    v_mul_f32 v14, v14, v46
    v_mul_f32 v15, v15, v47
    v_mul_f32 v16, v16, v48
    v_mul_f32 v17, v17, v49
    v_mul_f32 v18, v18, v50
    v_mul_f32 v19, v19, v51
    s_setprio 2
    v_cvt_pk_bf16_f32 v212, v4, v5
    v_cvt_pk_bf16_f32 v213, v6, v7
    v_mfma_f32_32x32x16_bf16 v[52:67], v[188:191], v[156:159], v[52:67]
    ds_read_b128 v[188:191], v230 offset:0
    v_cvt_pk_bf16_f32 v214, v8, v9
    v_cvt_pk_bf16_f32 v215, v10, v11
    v_cvt_pk_bf16_f32 v216, v12, v13
    v_cvt_pk_bf16_f32 v217, v14, v15
    v_cvt_pk_bf16_f32 v218, v16, v17
    v_cvt_pk_bf16_f32 v219, v18, v19
    v_mfma_f32_32x32x16_bf16 v[52:67], v[192:195], v[160:163], v[52:67]
    ds_read_b128 v[192:195], v231 offset:0
    v_add_u32 v243, 256, v243
    v_add_u32 v244, 256, v244
    s_waitcnt lgkmcnt(2)
    v_readfirstlane_b32 s3, v252
    v_add_u32 v245, 64, v245
    v_add_u32 v246, 256, v246
    s_sub_u32 s56, s56, 1
    s_mul_i32 s3, s3, s78
    s_cmp_lt_i32 s3, s79
    s_cbranch_scc0 M_s00
HM_s00:
    s_setprio 3
    v_exp_f32 v20, v20
    v_exp_f32 v21, v21
    v_smfmac_f32_32x32x32_bf16 v[68:83], v[208:211], v[212:219], v248
    ds_read2_b32 v[224:225], v246 offset0:0 offset1:8
    ds_read_b32 v3, v244 offset:128
    v_exp_f32 v22, v22
    v_exp_f32 v23, v23
    v_exp_f32 v24, v24
    v_exp_f32 v25, v25
    v_mfma_f32_32x32x16_bf16 v[4:19], v[204:207], v[172:175], 0
    v_exp_f32 v26, v26
    v_exp_f32 v27, v27
    v_exp_f32 v28, v28
    v_exp_f32 v29, v29
    v_mfma_f32_32x32x16_bf16 v[4:19], v[180:183], v[100:103], v[4:19]
    v_and_or_b32 v220, v220, s57, v238
    v_and_or_b32 v221, v221, s57, v239
    v_exp_f32 v30, v30
    v_exp_f32 v31, v31
    v_mfma_f32_32x32x16_bf16 v[36:51], v[180:183], v[132:135], 0
    v_and_or_b32 v222, v222, s57, v238
    v_and_or_b32 v223, v223, s57, v239
    v_exp_f32 v32, v32
    v_exp_f32 v33, v33
    v_exp_f32 v34, v34
    v_mfma_f32_32x32x16_bf16 v[4:19], v[184:187], v[104:107], v[4:19]
    v_exp_f32 v35, v35
    s_setprio 1
    s_waitcnt lgkmcnt(2)
    s_add_u32 m0, s55, 0
    s_nop 0
    buffer_load_dwordx4 v220, s[24:27], 0 offen  lds
    s_add_u32 m0, s55, 1024
    s_nop 0
    buffer_load_dwordx4 v221, s[24:27], 0 offen  lds
    v_add_f32 v20, 1.0, v20
    v_add_f32 v21, 1.0, v21
    v_add_f32 v22, 1.0, v22
    v_add_f32 v23, 1.0, v23
    v_add_f32 v24, 1.0, v24
    v_add_f32 v25, 1.0, v25
    v_add_f32 v26, 1.0, v26
    v_add_f32 v27, 1.0, v27
    v_add_f32 v28, 1.0, v28
    v_add_f32 v29, 1.0, v29
    v_add_f32 v30, 1.0, v30
    v_add_f32 v31, 1.0, v31
    v_add_f32 v32, 1.0, v32
    v_add_f32 v33, 1.0, v33
    v_add_f32 v34, 1.0, v34
    v_add_f32 v35, 1.0, v35
    s_setprio 3
    v_rcp_f32 v20, v20
    v_rcp_f32 v21, v21
    v_mfma_f32_32x32x16_bf16 v[36:51], v[184:187], v[136:139], v[36:51]
    v_rcp_f32 v22, v22
    v_rcp_f32 v23, v23
    v_rcp_f32 v24, v24
    v_rcp_f32 v25, v25
    v_mfma_f32_32x32x16_bf16 v[4:19], v[188:191], v[108:111], v[4:19]
    v_rcp_f32 v26, v26
    v_rcp_f32 v27, v27
    v_rcp_f32 v28, v28
    v_rcp_f32 v29, v29
    v_mfma_f32_32x32x16_bf16 v[4:19], v[192:195], v[112:115], v[4:19]
    v_rcp_f32 v30, v30
    v_rcp_f32 v31, v31
    v_rcp_f32 v32, v32
    s_waitcnt vmcnt(7)
    v_mfma_f32_32x32x16_bf16 v[4:19], v[196:199], v[164:167], v[4:19]
    v_rcp_f32 v33, v33
    v_rcp_f32 v34, v34
    v_rcp_f32 v35, v35
    s_setprio 1
    s_add_u32 m0, s55, 2048
    s_nop 0
    buffer_load_dwordx4 v222, s[24:27], 0 offen  lds
    s_add_u32 m0, s55, 3072
    s_nop 0
    buffer_load_dwordx4 v223, s[24:27], 0 offen  lds
    v_mul_f32 v20, v20, v52
    v_mul_f32 v21, v21, v53
    v_mul_f32 v22, v22, v54
    v_mul_f32 v23, v23, v55
    v_mul_f32 v24, v24, v56
    v_mul_f32 v25, v25, v57
    v_mul_f32 v26, v26, v58
    v_mul_f32 v27, v27, v59
    v_mul_f32 v28, v28, v60
    v_mul_f32 v29, v29, v61
    v_mul_f32 v30, v30, v62
    v_mul_f32 v31, v31, v63
    v_mul_f32 v32, v32, v64
    v_mul_f32 v33, v33, v65
    v_mul_f32 v34, v34, v66
    v_mul_f32 v35, v35, v67
    s_setprio 3
    v_cvt_pk_bf16_f32 v212, v20, v21
    v_mfma_f32_32x32x16_bf16 v[36:51], v[188:191], v[140:143], v[36:51]
    ds_read_b32 v236, v244 offset:256
    ds_read_u8 v237, v245 offset:64
    s_waitcnt lgkmcnt(3)
    v_bitop3_b32 v224, v224, s58, v240 bitop3:0x6a
    v_bitop3_b32 v225, v225, s58, v240 bitop3:0x6a
    v_cvt_pk_bf16_f32 v213, v22, v23
    v_cvt_pk_bf16_f32 v214, v24, v25
    v_cvt_pk_bf16_f32 v215, v26, v27
    v_cvt_pk_bf16_f32 v216, v28, v29
    v_cvt_pk_bf16_f32 v217, v30, v31
    v_mfma_f32_32x32x16_bf16 v[36:51], v[192:195], v[144:147], v[36:51]
    s_waitcnt lgkmcnt(2)
    v_bitop3_b32 v3, v3, s58, v242 bitop3:0x6a
    v_cvt_pk_bf16_f32 v218, v32, v33
    v_cvt_pk_bf16_f32 v219, v34, v35
    s_cmp_eq_u32 s56, 0
    s_cbranch_scc1 M_tail0
HM_s01:
    s_setprio 3
    v_exp_f32 v4, v4
    v_exp_f32 v5, v5
    v_smfmac_f32_32x32x32_bf16 v[84:99], v[208:211], v[212:219], v248
    ds_read_b64_tr_b16 v[208:209], v224 offset:128
    ds_read_b64_tr_b16 v[210:211], v225 offset:128
    v_exp_f32 v6, v6
    v_exp_f32 v7, v7
    v_exp_f32 v8, v8
    v_exp_f32 v9, v9
    v_mfma_f32_32x32x16_bf16 v[20:35], v[196:199], v[168:171], 0
    s_waitcnt lgkmcnt(3)
    v_alignbit_b32 v236, v236, v236, 18
    v_and_or_b32 v236, v236, s59, v241
    s_waitcnt lgkmcnt(2)
    v_mad_u32_u24 v236, v237, s60, v236
    v_exp_f32 v10, v10
    v_exp_f32 v11, v11
    v_mfma_f32_32x32x16_bf16 v[20:35], v[204:207], v[176:179], v[20:35]
    ds_read2_b64 v[204:207], v3 offset0:16 offset1:12
    v_exp_f32 v12, v12
    v_exp_f32 v13, v13
    v_exp_f32 v14, v14
    v_mfma_f32_32x32x16_bf16 v[20:35], v[180:183], v[116:119], v[20:35]
    v_exp_f32 v15, v15
    v_exp_f32 v16, v16
    v_exp_f32 v17, v17
    v_exp_f32 v18, v18
    v_mfma_f32_32x32x16_bf16 v[52:67], v[180:183], v[148:151], 0
    s_waitcnt vmcnt(5)
    ds_read_b128 v[180:183], v228 offset:4096
    v_exp_f32 v19, v19
    s_setprio 1
    buffer_load_dwordx4 v[196:199], v236, s[28:31], 0 offen
    v_add_f32 v4, 1.0, v4
    v_add_f32 v5, 1.0, v5
    v_add_f32 v6, 1.0, v6
    v_add_f32 v7, 1.0, v7
    v_add_f32 v8, 1.0, v8
    v_add_f32 v9, 1.0, v9
    v_add_f32 v10, 1.0, v10
    v_add_f32 v11, 1.0, v11
    v_add_f32 v12, 1.0, v12
    v_add_f32 v13, 1.0, v13
    v_add_f32 v14, 1.0, v14
    v_add_f32 v15, 1.0, v15
    v_add_f32 v16, 1.0, v16
    v_add_f32 v17, 1.0, v17
    v_add_f32 v18, 1.0, v18
    v_add_f32 v19, 1.0, v19
    s_setprio 3
    v_rcp_f32 v4, v4
    v_rcp_f32 v5, v5
    v_mfma_f32_32x32x16_bf16 v[20:35], v[184:187], v[120:123], v[20:35]
    v_rcp_f32 v6, v6
    v_rcp_f32 v7, v7
    v_rcp_f32 v8, v8
    v_mfma_f32_32x32x16_bf16 v[52:67], v[184:187], v[152:155], v[52:67]
    ds_read_b128 v[184:187], v229 offset:4096
    v_rcp_f32 v9, v9
    v_rcp_f32 v10, v10
    v_rcp_f32 v11, v11
    v_rcp_f32 v12, v12
    v_mfma_f32_32x32x16_bf16 v[20:35], v[188:191], v[124:127], v[20:35]
    v_rcp_f32 v13, v13
    v_rcp_f32 v14, v14
    v_rcp_f32 v15, v15
    v_mfma_f32_32x32x16_bf16 v[20:35], v[192:195], v[128:131], v[20:35]
    ds_read2_b64 v[220:223], v243 offset0:48 offset1:56
    s_mov_b64 exec, 1
    ds_add_rtn_u32 v252, v250, v251
    s_mov_b64 exec, -1
    v_rcp_f32 v16, v16
    v_rcp_f32 v17, v17
    v_rcp_f32 v18, v18
    v_rcp_f32 v19, v19
    s_setprio 1
    v_mul_f32 v4, v4, v36
    v_mul_f32 v5, v5, v37
    v_mul_f32 v6, v6, v38
    v_mul_f32 v7, v7, v39
    v_mul_f32 v8, v8, v40
    v_mul_f32 v9, v9, v41
    v_mul_f32 v10, v10, v42
    v_mul_f32 v11, v11, v43
    v_mul_f32 v12, v12, v44
    v_mul_f32 v13, v13, v45
    v_mul_f32 v14, v14, v46
    v_mul_f32 v15, v15, v47
    v_mul_f32 v16, v16, v48
    v_mul_f32 v17, v17, v49
    v_mul_f32 v18, v18, v50
    v_mul_f32 v19, v19, v51
    s_setprio 3
    v_mfma_f32_32x32x16_bf16 v[52:67], v[188:191], v[156:159], v[52:67]
    ds_read_b128 v[188:191], v230 offset:4096
    v_cvt_pk_bf16_f32 v212, v4, v5
    v_cvt_pk_bf16_f32 v213, v6, v7
    v_cvt_pk_bf16_f32 v214, v8, v9
    v_cvt_pk_bf16_f32 v215, v10, v11
    v_cvt_pk_bf16_f32 v216, v12, v13
    v_cvt_pk_bf16_f32 v217, v14, v15
    v_mfma_f32_32x32x16_bf16 v[52:67], v[192:195], v[160:163], v[52:67]
    ds_read_b128 v[192:195], v231 offset:4096
    s_waitcnt lgkmcnt(2)
    v_readfirstlane_b32 s3, v252
    v_cvt_pk_bf16_f32 v218, v16, v17
    v_cvt_pk_bf16_f32 v219, v18, v19
    s_sub_u32 s56, s56, 1
    s_mul_i32 s3, s3, s78
    s_cmp_lt_i32 s3, s79
    s_cbranch_scc0 M_s10
HM_s10:
    s_setprio 3
    v_exp_f32 v20, v20
    v_exp_f32 v21, v21
    v_smfmac_f32_32x32x32_bf16 v[68:83], v[208:211], v[212:219], v248
    ds_read2_b32 v[224:225], v246 offset0:32 offset1:40
    ds_read_b32 v3, v244 offset:256
    v_exp_f32 v22, v22
    v_exp_f32 v23, v23
    v_exp_f32 v24, v24
    v_exp_f32 v25, v25
    v_mfma_f32_32x32x16_bf16 v[4:19], v[204:207], v[172:175], 0
    v_exp_f32 v26, v26
    v_exp_f32 v27, v27
    v_exp_f32 v28, v28
    v_exp_f32 v29, v29
    v_mfma_f32_32x32x16_bf16 v[4:19], v[180:183], v[100:103], v[4:19]
    v_and_or_b32 v220, v220, s57, v238
    v_and_or_b32 v221, v221, s57, v239
    v_exp_f32 v30, v30
    v_exp_f32 v31, v31
    v_mfma_f32_32x32x16_bf16 v[36:51], v[180:183], v[132:135], 0
    v_and_or_b32 v222, v222, s57, v238
    v_and_or_b32 v223, v223, s57, v239
    v_exp_f32 v32, v32
    v_exp_f32 v33, v33
    v_exp_f32 v34, v34
    v_mfma_f32_32x32x16_bf16 v[4:19], v[184:187], v[104:107], v[4:19]
    v_exp_f32 v35, v35
    s_setprio 1
    s_waitcnt lgkmcnt(2)
    s_add_u32 m0, s55, 4096
    s_nop 0
    buffer_load_dwordx4 v220, s[24:27], 0 offen  lds
    s_add_u32 m0, s55, 5120
    s_nop 0
    buffer_load_dwordx4 v221, s[24:27], 0 offen  lds
    v_add_f32 v20, 1.0, v20
    v_add_f32 v21, 1.0, v21
    v_add_f32 v22, 1.0, v22
    v_add_f32 v23, 1.0, v23
    v_add_f32 v24, 1.0, v24
    v_add_f32 v25, 1.0, v25
    v_add_f32 v26, 1.0, v26
    v_add_f32 v27, 1.0, v27
    v_add_f32 v28, 1.0, v28
    v_add_f32 v29, 1.0, v29
    v_add_f32 v30, 1.0, v30
    v_add_f32 v31, 1.0, v31
    v_add_f32 v32, 1.0, v32
    v_add_f32 v33, 1.0, v33
    v_add_f32 v34, 1.0, v34
    v_add_f32 v35, 1.0, v35
    s_setprio 3
    v_rcp_f32 v20, v20
    v_rcp_f32 v21, v21
    v_mfma_f32_32x32x16_bf16 v[36:51], v[184:187], v[136:139], v[36:51]
    v_rcp_f32 v22, v22
    v_rcp_f32 v23, v23
    v_rcp_f32 v24, v24
    v_rcp_f32 v25, v25
    v_mfma_f32_32x32x16_bf16 v[4:19], v[188:191], v[108:111], v[4:19]
    v_rcp_f32 v26, v26
    v_rcp_f32 v27, v27
    v_rcp_f32 v28, v28
    v_rcp_f32 v29, v29
    v_mfma_f32_32x32x16_bf16 v[4:19], v[192:195], v[112:115], v[4:19]
    v_rcp_f32 v30, v30
    v_rcp_f32 v31, v31
    v_rcp_f32 v32, v32
    s_waitcnt vmcnt(7)
    v_mfma_f32_32x32x16_bf16 v[4:19], v[200:203], v[164:167], v[4:19]
    v_rcp_f32 v33, v33
    v_rcp_f32 v34, v34
    v_rcp_f32 v35, v35
    s_setprio 1
    s_add_u32 m0, s55, 6144
    s_nop 0
    buffer_load_dwordx4 v222, s[24:27], 0 offen  lds
    s_add_u32 m0, s55, 7168
    s_nop 0
    buffer_load_dwordx4 v223, s[24:27], 0 offen  lds
    v_mul_f32 v20, v20, v52
    v_mul_f32 v21, v21, v53
    v_mul_f32 v22, v22, v54
    v_mul_f32 v23, v23, v55
    v_mul_f32 v24, v24, v56
    v_mul_f32 v25, v25, v57
    v_mul_f32 v26, v26, v58
    v_mul_f32 v27, v27, v59
    v_mul_f32 v28, v28, v60
    v_mul_f32 v29, v29, v61
    v_mul_f32 v30, v30, v62
    v_mul_f32 v31, v31, v63
    v_mul_f32 v32, v32, v64
    v_mul_f32 v33, v33, v65
    v_mul_f32 v34, v34, v66
    v_mul_f32 v35, v35, v67
    s_setprio 3
    v_cvt_pk_bf16_f32 v212, v20, v21
    v_mfma_f32_32x32x16_bf16 v[36:51], v[188:191], v[140:143], v[36:51]
    ds_read_b32 v236, v244 offset:384
    ds_read_u8 v237, v245 offset:96
    s_waitcnt lgkmcnt(3)
    v_bitop3_b32 v224, v224, s58, v240 bitop3:0x6a
    v_bitop3_b32 v225, v225, s58, v240 bitop3:0x6a
    v_cvt_pk_bf16_f32 v213, v22, v23
    v_cvt_pk_bf16_f32 v214, v24, v25
    v_cvt_pk_bf16_f32 v215, v26, v27
    v_cvt_pk_bf16_f32 v216, v28, v29
    v_cvt_pk_bf16_f32 v217, v30, v31
    v_mfma_f32_32x32x16_bf16 v[36:51], v[192:195], v[144:147], v[36:51]
    s_waitcnt lgkmcnt(2)
    v_bitop3_b32 v3, v3, s58, v242 bitop3:0x6a
    v_cvt_pk_bf16_f32 v218, v32, v33
    v_cvt_pk_bf16_f32 v219, v34, v35
    s_cmp_eq_u32 s56, 0
    s_cbranch_scc1 M_tail1
HM_s11:
    s_setprio 3
    v_exp_f32 v4, v4
    v_exp_f32 v5, v5
    v_smfmac_f32_32x32x32_bf16 v[84:99], v[208:211], v[212:219], v248
    ds_read_b64_tr_b16 v[208:209], v224 offset:128
    ds_read_b64_tr_b16 v[210:211], v225 offset:128
    v_exp_f32 v6, v6
    v_exp_f32 v7, v7
    v_exp_f32 v8, v8
    v_exp_f32 v9, v9
    v_mfma_f32_32x32x16_bf16 v[20:35], v[200:203], v[168:171], 0
    s_waitcnt lgkmcnt(3)
    v_alignbit_b32 v236, v236, v236, 18
    v_and_or_b32 v236, v236, s59, v241
    s_waitcnt lgkmcnt(2)
    v_mad_u32_u24 v236, v237, s60, v236
    v_exp_f32 v10, v10
    v_exp_f32 v11, v11
    v_mfma_f32_32x32x16_bf16 v[20:35], v[204:207], v[176:179], v[20:35]
    ds_read2_b64 v[204:207], v3 offset0:16 offset1:12
    v_exp_f32 v12, v12
    v_exp_f32 v13, v13
    v_exp_f32 v14, v14
    v_exp_f32 v15, v15
    v_mfma_f32_32x32x16_bf16 v[20:35], v[180:183], v[116:119], v[20:35]
    v_exp_f32 v16, v16
    v_exp_f32 v17, v17
    v_exp_f32 v18, v18
    v_mfma_f32_32x32x16_bf16 v[52:67], v[180:183], v[148:151], 0
    s_waitcnt vmcnt(5)
    ds_read_b128 v[180:183], v228 offset:0
    v_exp_f32 v19, v19
    s_setprio 1
    buffer_load_dwordx4 v[200:203], v236, s[28:31], 0 offen
    v_add_f32 v4, 1.0, v4
    v_add_f32 v5, 1.0, v5
    v_add_f32 v6, 1.0, v6
    v_add_f32 v7, 1.0, v7
    v_add_f32 v8, 1.0, v8
    v_add_f32 v9, 1.0, v9
    v_add_f32 v10, 1.0, v10
    v_add_f32 v11, 1.0, v11
    v_add_f32 v12, 1.0, v12
    v_add_f32 v13, 1.0, v13
    v_add_f32 v14, 1.0, v14
    v_add_f32 v15, 1.0, v15
    v_add_f32 v16, 1.0, v16
    v_add_f32 v17, 1.0, v17
    v_add_f32 v18, 1.0, v18
    v_add_f32 v19, 1.0, v19
    s_setprio 3
    v_rcp_f32 v4, v4
    v_rcp_f32 v5, v5
    v_rcp_f32 v6, v6
    v_mfma_f32_32x32x16_bf16 v[20:35], v[184:187], v[120:123], v[20:35]
    v_rcp_f32 v7, v7
    v_rcp_f32 v8, v8
    v_rcp_f32 v9, v9
    v_rcp_f32 v10, v10
    v_mfma_f32_32x32x16_bf16 v[52:67], v[184:187], v[152:155], v[52:67]
    ds_read_b128 v[184:187], v229 offset:0
    v_rcp_f32 v11, v11
    v_rcp_f32 v12, v12
    v_rcp_f32 v13, v13
    v_mfma_f32_32x32x16_bf16 v[20:35], v[188:191], v[124:127], v[20:35]
    v_rcp_f32 v14, v14
    v_rcp_f32 v15, v15
    v_rcp_f32 v16, v16
    v_rcp_f32 v17, v17
    v_mfma_f32_32x32x16_bf16 v[20:35], v[192:195], v[128:131], v[20:35]
    ds_read2_b64 v[220:223], v243 offset0:64 offset1:72
    s_mov_b64 exec, 1
    ds_add_rtn_u32 v252, v250, v251
    s_mov_b64 exec, -1
    v_rcp_f32 v18, v18
    v_rcp_f32 v19, v19
    s_setprio 1
    v_mul_f32 v4, v4, v36
    v_mul_f32 v5, v5, v37
    v_mul_f32 v6, v6, v38
    v_mul_f32 v7, v7, v39
    v_mul_f32 v8, v8, v40
    v_mul_f32 v9, v9, v41
    v_mul_f32 v10, v10, v42
    v_mul_f32 v11, v11, v43
    v_mul_f32 v12, v12, v44
    v_mul_f32 v13, v13, v45
    v_mul_f32 v14, v14, v46
    v_mul_f32 v15, v15, v47
    v_mul_f32 v16, v16, v48
    v_mul_f32 v17, v17, v49
    v_mul_f32 v18, v18, v50
    v_mul_f32 v19, v19, v51
    s_setprio 3
    v_cvt_pk_bf16_f32 v212, v4, v5
    v_cvt_pk_bf16_f32 v213, v6, v7
    v_mfma_f32_32x32x16_bf16 v[52:67], v[188:191], v[156:159], v[52:67]
    ds_read_b128 v[188:191], v230 offset:0
    v_cvt_pk_bf16_f32 v214, v8, v9
    v_cvt_pk_bf16_f32 v215, v10, v11
    v_cvt_pk_bf16_f32 v216, v12, v13
    v_cvt_pk_bf16_f32 v217, v14, v15
    v_cvt_pk_bf16_f32 v218, v16, v17
    v_cvt_pk_bf16_f32 v219, v18, v19
    v_mfma_f32_32x32x16_bf16 v[52:67], v[192:195], v[160:163], v[52:67]
    ds_read_b128 v[192:195], v231 offset:0
    v_add_u32 v243, 256, v243
    v_add_u32 v244, 256, v244
    s_waitcnt lgkmcnt(2)
    v_readfirstlane_b32 s3, v252
    v_add_u32 v245, 64, v245
    v_add_u32 v246, 256, v246
    s_sub_u32 s56, s56, 1
    s_mul_i32 s3, s3, s78
    s_cmp_lt_i32 s3, s79
    s_cbranch_scc1 HM_s00
    s_branch M_s00
M_tail0:
    s_waitcnt lgkmcnt(0)
    s_setprio 2
    v_smfmac_f32_32x32x32_bf16 v[84:99], v[208:211], v[212:219], v248
    ds_read_b64_tr_b16 v[208:209], v224 offset:128
    ds_read_b64_tr_b16 v[210:211], v225 offset:128
    v_mfma_f32_32x32x16_bf16 v[20:35], v[196:199], v[168:171], 0
    s_branch M_tailc
M_tail1:
    s_waitcnt lgkmcnt(0)
    s_setprio 2
    v_smfmac_f32_32x32x32_bf16 v[84:99], v[208:211], v[212:219], v248
    ds_read_b64_tr_b16 v[208:209], v224 offset:128
    ds_read_b64_tr_b16 v[210:211], v225 offset:128
    v_mfma_f32_32x32x16_bf16 v[20:35], v[200:203], v[168:171], 0
M_tailc:
    s_mov_b64 exec, 1
    ds_add_u32 v250, v251
    s_mov_b64 exec, -1
    s_add_u32 s3, s63, 31
    s_bitcmp0_b32 s3, 4
    s_cbranch_scc1 M_tailh
    s_setprio 2
    v_exp_f32 v4, v4
    v_exp_f32 v5, v5
    v_mfma_f32_32x32x16_bf16 v[20:35], v[204:207], v[176:179], v[20:35]
    v_exp_f32 v6, v6
    v_exp_f32 v7, v7
    v_exp_f32 v8, v8
    v_exp_f32 v9, v9
    v_mfma_f32_32x32x16_bf16 v[20:35], v[180:183], v[116:119], v[20:35]
    v_exp_f32 v10, v10
    v_exp_f32 v11, v11
    v_exp_f32 v12, v12
    v_exp_f32 v13, v13
    v_mfma_f32_32x32x16_bf16 v[20:35], v[184:187], v[120:123], v[20:35]
    v_exp_f32 v14, v14
    v_exp_f32 v15, v15
    v_exp_f32 v16, v16
    v_exp_f32 v17, v17
    v_mfma_f32_32x32x16_bf16 v[20:35], v[188:191], v[124:127], v[20:35]
    v_exp_f32 v18, v18
    v_exp_f32 v19, v19
    s_setprio 0
    v_add_f32 v4, 1.0, v4
    v_add_f32 v5, 1.0, v5
    v_add_f32 v6, 1.0, v6
    v_add_f32 v7, 1.0, v7
    v_add_f32 v8, 1.0, v8
    v_add_f32 v9, 1.0, v9
    v_add_f32 v10, 1.0, v10
    v_add_f32 v11, 1.0, v11
    v_add_f32 v12, 1.0, v12
    v_add_f32 v13, 1.0, v13
    v_add_f32 v14, 1.0, v14
    v_add_f32 v15, 1.0, v15
    v_add_f32 v16, 1.0, v16
    v_add_f32 v17, 1.0, v17
    v_add_f32 v18, 1.0, v18
    v_add_f32 v19, 1.0, v19
    s_setprio 2
    v_rcp_f32 v4, v4
    v_rcp_f32 v5, v5
    v_mfma_f32_32x32x16_bf16 v[20:35], v[192:195], v[128:131], v[20:35]
    v_rcp_f32 v6, v6
    v_rcp_f32 v7, v7
    v_rcp_f32 v8, v8
    v_rcp_f32 v9, v9
    v_mfma_f32_32x32x16_bf16 v[52:67], v[180:183], v[148:151], 0
    v_rcp_f32 v10, v10
    v_rcp_f32 v11, v11
    v_rcp_f32 v12, v12
    v_rcp_f32 v13, v13
    v_mfma_f32_32x32x16_bf16 v[52:67], v[184:187], v[152:155], v[52:67]
    v_rcp_f32 v14, v14
    v_rcp_f32 v15, v15
    v_rcp_f32 v16, v16
    v_rcp_f32 v17, v17
    v_mfma_f32_32x32x16_bf16 v[52:67], v[188:191], v[156:159], v[52:67]
    v_rcp_f32 v18, v18
    v_rcp_f32 v19, v19
    s_setprio 0
    v_mul_f32 v4, v4, v36
    v_mul_f32 v5, v5, v37
    v_mul_f32 v6, v6, v38
    v_mul_f32 v7, v7, v39
    v_mul_f32 v8, v8, v40
    v_mul_f32 v9, v9, v41
    v_mul_f32 v10, v10, v42
    v_mul_f32 v11, v11, v43
    v_mul_f32 v12, v12, v44
    v_mul_f32 v13, v13, v45
    v_mul_f32 v14, v14, v46
    v_mul_f32 v15, v15, v47
    v_mul_f32 v16, v16, v48
    v_mul_f32 v17, v17, v49
    v_mul_f32 v18, v18, v50
    v_mul_f32 v19, v19, v51
    s_setprio 2
    v_cvt_pk_bf16_f32 v212, v4, v5
    v_cvt_pk_bf16_f32 v213, v6, v7
    v_cvt_pk_bf16_f32 v214, v8, v9
    v_cvt_pk_bf16_f32 v215, v10, v11
    v_mfma_f32_32x32x16_bf16 v[52:67], v[192:195], v[160:163], v[52:67]
    v_cvt_pk_bf16_f32 v216, v12, v13
    v_cvt_pk_bf16_f32 v217, v14, v15
    v_cvt_pk_bf16_f32 v218, v16, v17
    v_cvt_pk_bf16_f32 v219, v18, v19
    s_setprio 2
    v_exp_f32 v20, v20
    v_exp_f32 v21, v21
    s_waitcnt lgkmcnt(1)
    v_smfmac_f32_32x32x32_bf16 v[68:83], v[208:211], v[212:219], v248
    v_exp_f32 v22, v22
    v_exp_f32 v23, v23
    v_exp_f32 v24, v24
    v_exp_f32 v25, v25
    v_exp_f32 v26, v26
    v_exp_f32 v27, v27
    v_exp_f32 v28, v28
    v_exp_f32 v29, v29
    v_exp_f32 v30, v30
    v_exp_f32 v31, v31
    v_exp_f32 v32, v32
    v_exp_f32 v33, v33
    v_exp_f32 v34, v34
    v_exp_f32 v35, v35
    s_setprio 0
    v_add_f32 v20, 1.0, v20
    v_add_f32 v21, 1.0, v21
    v_add_f32 v22, 1.0, v22
    v_add_f32 v23, 1.0, v23
    v_add_f32 v24, 1.0, v24
    v_add_f32 v25, 1.0, v25
    v_add_f32 v26, 1.0, v26
    v_add_f32 v27, 1.0, v27
    v_add_f32 v28, 1.0, v28
    v_add_f32 v29, 1.0, v29
    v_add_f32 v30, 1.0, v30
    v_add_f32 v31, 1.0, v31
    v_add_f32 v32, 1.0, v32
    v_add_f32 v33, 1.0, v33
    v_add_f32 v34, 1.0, v34
    v_add_f32 v35, 1.0, v35
    s_setprio 2
    v_rcp_f32 v20, v20
    v_rcp_f32 v21, v21
    v_rcp_f32 v22, v22
    v_rcp_f32 v23, v23
    v_rcp_f32 v24, v24
    v_rcp_f32 v25, v25
    v_rcp_f32 v26, v26
    v_rcp_f32 v27, v27
    v_rcp_f32 v28, v28
    v_rcp_f32 v29, v29
    v_rcp_f32 v30, v30
    v_rcp_f32 v31, v31
    v_rcp_f32 v32, v32
    v_rcp_f32 v33, v33
    v_rcp_f32 v34, v34
    v_rcp_f32 v35, v35
    s_setprio 0
    v_mul_f32 v20, v20, v52
    v_mul_f32 v21, v21, v53
    v_mul_f32 v22, v22, v54
    v_mul_f32 v23, v23, v55
    v_mul_f32 v24, v24, v56
    v_mul_f32 v25, v25, v57
    v_mul_f32 v26, v26, v58
    v_mul_f32 v27, v27, v59
    v_mul_f32 v28, v28, v60
    v_mul_f32 v29, v29, v61
    v_mul_f32 v30, v30, v62
    v_mul_f32 v31, v31, v63
    v_mul_f32 v32, v32, v64
    v_mul_f32 v33, v33, v65
    v_mul_f32 v34, v34, v66
    v_mul_f32 v35, v35, v67
    s_setprio 2
    v_cvt_pk_bf16_f32 v212, v20, v21
    v_cvt_pk_bf16_f32 v213, v22, v23
    v_cvt_pk_bf16_f32 v214, v24, v25
    v_cvt_pk_bf16_f32 v215, v26, v27
    v_cvt_pk_bf16_f32 v216, v28, v29
    v_cvt_pk_bf16_f32 v217, v30, v31
    v_cvt_pk_bf16_f32 v218, v32, v33
    v_cvt_pk_bf16_f32 v219, v34, v35
    s_nop 1
    v_smfmac_f32_32x32x32_bf16 v[84:99], v[208:211], v[212:219], v248
M_after0:
    s_or_b32 s3, s61, s64
    s_cbranch_scc1 M_again
M_fin:
    s_mov_b32 s3, 0xbfb8aa3b
    s_movk_i32 s66, 0x780
    v_and_b32 v236, 31, v1
    v_lshlrev_b32 v236, 2, v236
    v_add_u32 v180, 0, v2
    v_add_u32 v181, 128, v2
    v_add_u32 v182, 256, v2
    v_add_u32 v183, 384, v2
    v_add_u32 v184, 512, v2
    v_add_u32 v185, 640, v2
    v_add_u32 v186, 768, v2
    v_add_u32 v187, 896, v2
    v_and_or_b32 v180, v180, s66, v236
    v_and_or_b32 v181, v181, s66, v236
    v_and_or_b32 v182, v182, s66, v236
    v_and_or_b32 v183, v183, s66, v236
    v_and_or_b32 v184, v184, s66, v236
    v_and_or_b32 v185, v185, s66, v236
    v_and_or_b32 v186, v186, s66, v236
    v_and_or_b32 v187, v187, s66, v236
    v_add_f32 v36, v68, v76
    v_add_f32 v38, v69, v77
    v_add_f32 v40, v70, v78
    v_add_f32 v42, v71, v79
    v_add_f32 v44, v72, v80
    v_add_f32 v46, v73, v81
    v_add_f32 v48, v74, v82
    v_add_f32 v50, v75, v83
    v_add_f32 v37, v84, v92
    v_add_f32 v39, v85, v93
    v_add_f32 v41, v86, v94
    v_add_f32 v43, v87, v95
    v_add_f32 v45, v88, v96
    v_add_f32 v47, v89, v97
    v_add_f32 v49, v90, v98
    v_add_f32 v51, v91, v99
    v_mul_f32 v4, s3, v36
    v_mul_f32 v5, s3, v37
    v_mul_f32 v6, s3, v38
    v_mul_f32 v7, s3, v39
    v_mul_f32 v8, s3, v40
    v_mul_f32 v9, s3, v41
    v_mul_f32 v10, s3, v42
    v_mul_f32 v11, s3, v43
    v_mul_f32 v12, s3, v44
    v_mul_f32 v13, s3, v45
    v_mul_f32 v14, s3, v46
    v_mul_f32 v15, s3, v47
    v_mul_f32 v16, s3, v48
    v_mul_f32 v17, s3, v49
    v_mul_f32 v18, s3, v50
    v_mul_f32 v19, s3, v51
    v_exp_f32 v4, v4
    v_exp_f32 v5, v5
    v_exp_f32 v6, v6
    v_exp_f32 v7, v7
    v_exp_f32 v8, v8
    v_exp_f32 v9, v9
    v_exp_f32 v10, v10
    v_exp_f32 v11, v11
    v_exp_f32 v12, v12
    v_exp_f32 v13, v13
    v_exp_f32 v14, v14
    v_exp_f32 v15, v15
    v_exp_f32 v16, v16
    v_exp_f32 v17, v17
    v_exp_f32 v18, v18
    v_exp_f32 v19, v19
    v_add_f32 v4, 1.0, v4
    v_add_f32 v5, 1.0, v5
    v_add_f32 v6, 1.0, v6
    v_add_f32 v7, 1.0, v7
    v_add_f32 v8, 1.0, v8
    v_add_f32 v9, 1.0, v9
    v_add_f32 v10, 1.0, v10
    v_add_f32 v11, 1.0, v11
    v_add_f32 v12, 1.0, v12
    v_add_f32 v13, 1.0, v13
    v_add_f32 v14, 1.0, v14
    v_add_f32 v15, 1.0, v15
    v_add_f32 v16, 1.0, v16
    v_add_f32 v17, 1.0, v17
    v_add_f32 v18, 1.0, v18
    v_add_f32 v19, 1.0, v19
    v_rcp_f32 v4, v4
    v_rcp_f32 v5, v5
    v_rcp_f32 v6, v6
    v_rcp_f32 v7, v7
    v_rcp_f32 v8, v8
    v_rcp_f32 v9, v9
    v_rcp_f32 v10, v10
    v_rcp_f32 v11, v11
    v_rcp_f32 v12, v12
    v_rcp_f32 v13, v13
    v_rcp_f32 v14, v14
    v_rcp_f32 v15, v15
    v_rcp_f32 v16, v16
    v_rcp_f32 v17, v17
    v_rcp_f32 v18, v18
    v_rcp_f32 v19, v19
    v_mul_f32 v4, v4, v36
    v_mul_f32 v5, v5, v37
    v_mul_f32 v6, v6, v38
    v_mul_f32 v7, v7, v39
    v_mul_f32 v8, v8, v40
    v_mul_f32 v9, v9, v41
    v_mul_f32 v10, v10, v42
    v_mul_f32 v11, v11, v43
    v_mul_f32 v12, v12, v44
    v_mul_f32 v13, v13, v45
    v_mul_f32 v14, v14, v46
    v_mul_f32 v15, v15, v47
    v_mul_f32 v16, v16, v48
    v_mul_f32 v17, v17, v49
    v_mul_f32 v18, v18, v50
    v_mul_f32 v19, v19, v51
    v_cvt_pk_bf16_f32 v212, v4, v5
    v_cvt_pk_bf16_f32 v213, v6, v7
    buffer_store_dword v212, v180, s[40:43], 0 offen sc1
    v_cvt_pk_bf16_f32 v214, v8, v9
    buffer_store_dword v213, v181, s[40:43], 0 offen sc1
    v_cvt_pk_bf16_f32 v215, v10, v11
    buffer_store_dword v214, v182, s[40:43], 0 offen sc1
    v_cvt_pk_bf16_f32 v216, v12, v13
    buffer_store_dword v215, v183, s[40:43], 0 offen sc1
    v_cvt_pk_bf16_f32 v217, v14, v15
    buffer_store_dword v216, v184, s[40:43], 0 offen sc1
    v_cvt_pk_bf16_f32 v218, v16, v17
    buffer_store_dword v217, v185, s[40:43], 0 offen sc1
    v_cvt_pk_bf16_f32 v219, v18, v19
    buffer_store_dword v218, v186, s[40:43], 0 offen sc1
    buffer_store_dword v219, v187, s[40:43], 0 offen sc1
M_end:
    s_endpgm
M_tailh:
    v_mov_b32 v216, 0
    v_mov_b32 v217, 0
    v_mov_b32 v218, 0
    v_mov_b32 v219, 0
    s_setprio 2
    v_exp_f32 v4, v4
    v_exp_f32 v5, v5
    v_mfma_f32_32x32x16_bf16 v[20:35], v[204:207], v[176:179], v[20:35]
    v_exp_f32 v6, v6
    v_exp_f32 v7, v7
    v_mfma_f32_32x32x16_bf16 v[20:35], v[180:183], v[116:119], v[20:35]
    v_exp_f32 v8, v8
    v_exp_f32 v9, v9
    v_mfma_f32_32x32x16_bf16 v[20:35], v[184:187], v[120:123], v[20:35]
    v_exp_f32 v10, v10
    v_exp_f32 v11, v11
    s_setprio 0
    v_add_f32 v4, 1.0, v4
    v_add_f32 v5, 1.0, v5
    v_add_f32 v6, 1.0, v6
    v_add_f32 v7, 1.0, v7
    v_add_f32 v8, 1.0, v8
    v_add_f32 v9, 1.0, v9
    v_add_f32 v10, 1.0, v10
    v_add_f32 v11, 1.0, v11
    s_setprio 2
    v_mfma_f32_32x32x16_bf16 v[20:35], v[188:191], v[124:127], v[20:35]
    v_rcp_f32 v4, v4
    v_rcp_f32 v5, v5
    v_mfma_f32_32x32x16_bf16 v[20:35], v[192:195], v[128:131], v[20:35]
    v_rcp_f32 v6, v6
    v_rcp_f32 v7, v7
    v_mfma_f32_32x32x16_bf16 v[52:67], v[180:183], v[148:151], 0
    v_rcp_f32 v8, v8
    v_rcp_f32 v9, v9
    v_mfma_f32_32x32x16_bf16 v[52:67], v[184:187], v[152:155], v[52:67]
    v_rcp_f32 v10, v10
    v_rcp_f32 v11, v11
    s_setprio 0
    v_mul_f32 v4, v4, v36
    v_mul_f32 v5, v5, v37
    v_mul_f32 v6, v6, v38
    v_mul_f32 v7, v7, v39
    v_mul_f32 v8, v8, v40
    v_mul_f32 v9, v9, v41
    v_mul_f32 v10, v10, v42
    v_mul_f32 v11, v11, v43
    s_setprio 2
    v_mfma_f32_32x32x16_bf16 v[52:67], v[188:191], v[156:159], v[52:67]
    v_cvt_pk_bf16_f32 v212, v4, v5
    v_cvt_pk_bf16_f32 v213, v6, v7
    v_cvt_pk_bf16_f32 v214, v8, v9
    v_cvt_pk_bf16_f32 v215, v10, v11
    v_mfma_f32_32x32x16_bf16 v[52:67], v[192:195], v[160:163], v[52:67]
    s_setprio 2
    v_exp_f32 v20, v20
    v_exp_f32 v21, v21
    s_waitcnt lgkmcnt(1)
    v_smfmac_f32_32x32x32_bf16 v[68:83], v[208:211], v[212:219], v248
    v_exp_f32 v22, v22
    v_exp_f32 v23, v23
    v_exp_f32 v24, v24
    v_exp_f32 v25, v25
    v_exp_f32 v26, v26
    v_exp_f32 v27, v27
    s_setprio 0
    v_add_f32 v20, 1.0, v20
    v_add_f32 v21, 1.0, v21
    v_add_f32 v22, 1.0, v22
    v_add_f32 v23, 1.0, v23
    v_add_f32 v24, 1.0, v24
    v_add_f32 v25, 1.0, v25
    v_add_f32 v26, 1.0, v26
    v_add_f32 v27, 1.0, v27
    s_setprio 2
    v_rcp_f32 v20, v20
    v_rcp_f32 v21, v21
    v_rcp_f32 v22, v22
    v_rcp_f32 v23, v23
    v_rcp_f32 v24, v24
    v_rcp_f32 v25, v25
    v_rcp_f32 v26, v26
    v_rcp_f32 v27, v27
    s_setprio 0
    v_mul_f32 v20, v20, v52
    v_mul_f32 v21, v21, v53
    v_mul_f32 v22, v22, v54
    v_mul_f32 v23, v23, v55
    v_mul_f32 v24, v24, v56
    v_mul_f32 v25, v25, v57
    v_mul_f32 v26, v26, v58
    v_mul_f32 v27, v27, v59
    s_setprio 2
    v_cvt_pk_bf16_f32 v212, v20, v21
    v_cvt_pk_bf16_f32 v213, v22, v23
    v_cvt_pk_bf16_f32 v214, v24, v25
    v_cvt_pk_bf16_f32 v215, v26, v27
    s_nop 1
    v_smfmac_f32_32x32x32_bf16 v[84:99], v[208:211], v[212:219], v248
    s_branch M_after0
P_spare:
    s_cmp_lg_u32 s2, 255
    s_cbranch_scc1 P_sp2
    s_add_u32 s44, s22, 8388608
    s_addc_u32 s45, s23, 0
    s_mov_b32 s46, 12288
    s_mov_b32 s47, 0x20000
    s_mov_b32 s48, s20
    s_mov_b32 s49, s21
    s_mov_b32 s50, 4
    s_mov_b32 s51, 0x20000
    v_lshlrev_b32 v220, 7, v0
    v_mov_b32 v221, 1
    s_mov_b32 s3, 0
    buffer_store_dwordx4 v[184:187], v180, s[44:47], s3 offen sc1
    s_mov_b32 s3, 8192
    buffer_store_dwordx4 v[184:187], v180, s[44:47], s3 offen sc1
    s_waitcnt vmcnt(0)
    s_barrier
    buffer_store_dword v221, v220, s[48:51], 0 offen sc1
P_sp2:
    s_mov_b32 s28, s16
    s_mov_b32 s29, s17
    s_mov_b32 s30, 18432
    s_mov_b32 s31, 0x20000
    s_mov_b32 s32, s14
    s_mov_b32 s33, s15
    s_mov_b32 s34, 8192
    s_mov_b32 s35, 0x20000
    s_mov_b32 s40, s12
    s_mov_b32 s41, s13
    s_mov_b32 s42, 8192
    s_mov_b32 s43, 0x20000
    v_lshlrev_b32 v220, 7, v0
    buffer_load_dword v254, v220, s[28:31], 0 offen
    buffer_load_dword v254, v220, s[32:35], 0 offen
    buffer_load_dword v254, v220, s[40:43], 0 offen
    s_bfe_u32 s3, s2, 0x50002
    s_lshl_b32 s3, s3, 3
    s_lshr_b32 s66, s2, 7
    s_lshl_b32 s66, s66, 2
    s_add_u32 s3, s3, s66
    s_and_b32 s66, s2, 3
    s_add_u32 s3, s3, s66
    s_lshl_b32 s3, s3, 7
    s_add_u32 s44, s22, s3
    s_addc_u32 s45, s23, 0
    s_mov_b32 s46, 8355968
    s_mov_b32 s47, 0x20000
    buffer_store_dwordx4 v[184:187], v182, s[44:47], 0 offen sc1
    s_mov_b32 s3, 2097152
    buffer_store_dwordx4 v[184:187], v182, s[44:47], s3 offen sc1
    s_mov_b32 s3, 4194304
    buffer_store_dwordx4 v[184:187], v182, s[44:47], s3 offen sc1
    s_mov_b32 s3, 6291456
    buffer_store_dwordx4 v[184:187], v182, s[44:47], s3 offen sc1
    s_branch P_join
P_ovf0:
    s_mov_b64 s[66:67], exec
    v_cmpx_gt_u32 vcc, 30, v140
    ds_write_b32 v132, v148 offset:8712
    s_andn2_b64 exec, s[66:67], vcc
    s_cbranch_execz P_on0
    ds_add_rtn_u32 v36, v184, v181 offset:45568
    v_mov_b32 v38, v148
    v_lshrrev_b32 v39, 2, v116
    s_waitcnt lgkmcnt(0)
    v_lshlrev_b32 v36, 3, v36
    s_mov_b64 s[68:69], exec
    v_cmpx_gt_u32 vcc, 120, v36
    ds_write_b64 v36, v[38:39] offset:45576
    s_andn2_b64 exec, s[68:69], vcc
    s_cbranch_execz P_on0
    buffer_store_dwordx2 v[38:39], v36, s[48:51], 0 offen offset:8 sc1
P_on0:
    s_mov_b64 exec, s[66:67]
    v_cmpx_gt_u32 vcc, 30, v141
    ds_write_b32 v133, v149 offset:8712
    s_andn2_b64 exec, s[66:67], vcc
    s_cbranch_execz P_on1
    ds_add_rtn_u32 v40, v184, v181 offset:45568
    v_mov_b32 v42, v149
    v_lshrrev_b32 v43, 2, v117
    s_waitcnt lgkmcnt(0)
    v_lshlrev_b32 v40, 3, v40
    s_mov_b64 s[68:69], exec
    v_cmpx_gt_u32 vcc, 120, v40
    ds_write_b64 v40, v[42:43] offset:45576
    s_andn2_b64 exec, s[68:69], vcc
    s_cbranch_execz P_on1
    buffer_store_dwordx2 v[42:43], v40, s[48:51], 0 offen offset:8 sc1
P_on1:
    s_mov_b64 exec, s[66:67]
    v_cmpx_gt_u32 vcc, 30, v142
    ds_write_b32 v134, v150 offset:8712
    s_andn2_b64 exec, s[66:67], vcc
    s_cbranch_execz P_on2
    ds_add_rtn_u32 v44, v184, v181 offset:45568
    v_mov_b32 v46, v150
    v_lshrrev_b32 v47, 2, v118
    s_waitcnt lgkmcnt(0)
    v_lshlrev_b32 v44, 3, v44
    s_mov_b64 s[68:69], exec
    v_cmpx_gt_u32 vcc, 120, v44
    ds_write_b64 v44, v[46:47] offset:45576
    s_andn2_b64 exec, s[68:69], vcc
    s_cbranch_execz P_on2
    buffer_store_dwordx2 v[46:47], v44, s[48:51], 0 offen offset:8 sc1
P_on2:
    s_mov_b64 exec, s[66:67]
    v_cmpx_gt_u32 vcc, 30, v143
    ds_write_b32 v135, v151 offset:8712
    s_andn2_b64 exec, s[66:67], vcc
    s_cbranch_execz P_on3
    ds_add_rtn_u32 v48, v184, v181 offset:45568
    v_mov_b32 v50, v151
    v_lshrrev_b32 v51, 2, v119
    s_waitcnt lgkmcnt(0)
    v_lshlrev_b32 v48, 3, v48
    s_mov_b64 s[68:69], exec
    v_cmpx_gt_u32 vcc, 120, v48
    ds_write_b64 v48, v[50:51] offset:45576
    s_andn2_b64 exec, s[68:69], vcc
    s_cbranch_execz P_on3
    buffer_store_dwordx2 v[50:51], v48, s[48:51], 0 offen offset:8 sc1
P_on3:
    s_mov_b64 exec, s[66:67]
    s_branch P_sc0
P_ovf1:
    s_mov_b64 s[66:67], exec
    v_cmpx_gt_u32 vcc, 30, v144
    ds_write_b32 v136, v152 offset:8712
    s_andn2_b64 exec, s[66:67], vcc
    s_cbranch_execz P_on4
    ds_add_rtn_u32 v52, v184, v181 offset:45568
    v_mov_b32 v54, v152
    v_lshrrev_b32 v55, 2, v120
    s_waitcnt lgkmcnt(0)
    v_lshlrev_b32 v52, 3, v52
    s_mov_b64 s[68:69], exec
    v_cmpx_gt_u32 vcc, 120, v52
    ds_write_b64 v52, v[54:55] offset:45576
    s_andn2_b64 exec, s[68:69], vcc
    s_cbranch_execz P_on4
    buffer_store_dwordx2 v[54:55], v52, s[48:51], 0 offen offset:8 sc1
P_on4:
    s_mov_b64 exec, s[66:67]
    v_cmpx_gt_u32 vcc, 30, v145
    ds_write_b32 v137, v153 offset:8712
    s_andn2_b64 exec, s[66:67], vcc
    s_cbranch_execz P_on5
    ds_add_rtn_u32 v56, v184, v181 offset:45568
    v_mov_b32 v58, v153
    v_lshrrev_b32 v59, 2, v121
    s_waitcnt lgkmcnt(0)
    v_lshlrev_b32 v56, 3, v56
    s_mov_b64 s[68:69], exec
    v_cmpx_gt_u32 vcc, 120, v56
    ds_write_b64 v56, v[58:59] offset:45576
    s_andn2_b64 exec, s[68:69], vcc
    s_cbranch_execz P_on5
    buffer_store_dwordx2 v[58:59], v56, s[48:51], 0 offen offset:8 sc1
P_on5:
    s_mov_b64 exec, s[66:67]
    v_cmpx_gt_u32 vcc, 30, v146
    ds_write_b32 v138, v154 offset:8712
    s_andn2_b64 exec, s[66:67], vcc
    s_cbranch_execz P_on6
    ds_add_rtn_u32 v60, v184, v181 offset:45568
    v_mov_b32 v62, v154
    v_lshrrev_b32 v63, 2, v122
    s_waitcnt lgkmcnt(0)
    v_lshlrev_b32 v60, 3, v60
    s_mov_b64 s[68:69], exec
    v_cmpx_gt_u32 vcc, 120, v60
    ds_write_b64 v60, v[62:63] offset:45576
    s_andn2_b64 exec, s[68:69], vcc
    s_cbranch_execz P_on6
    buffer_store_dwordx2 v[62:63], v60, s[48:51], 0 offen offset:8 sc1
P_on6:
    s_mov_b64 exec, s[66:67]
    v_cmpx_gt_u32 vcc, 30, v147
    ds_write_b32 v139, v155 offset:8712
    s_andn2_b64 exec, s[66:67], vcc
    s_cbranch_execz P_on7
    ds_add_rtn_u32 v64, v184, v181 offset:45568
    v_mov_b32 v66, v155
    v_lshrrev_b32 v67, 2, v123
    s_waitcnt lgkmcnt(0)
    v_lshlrev_b32 v64, 3, v64
    s_mov_b64 s[68:69], exec
    v_cmpx_gt_u32 vcc, 120, v64
    ds_write_b64 v64, v[66:67] offset:45576
    s_andn2_b64 exec, s[68:69], vcc
    s_cbranch_execz P_on7
    buffer_store_dwordx2 v[66:67], v64, s[48:51], 0 offen offset:8 sc1
P_on7:
    s_mov_b64 exec, s[66:67]
    s_branch P_sc1
M_setovf:
    s_mov_b32 s64, 1
    v_mov_b32 v222, 1966110
    v_cmp_le_u32 vcc, 2031616, v232
    v_mov_b32 v220, 1
    s_nop 1
    v_cndmask_b32 v220, 0, v220, vcc
    v_or_b32 v247, v247, v220
    v_pk_min_u16 v232, v232, v222
    v_cmp_le_u32 vcc, 2031616, v233
    v_mov_b32 v220, 2
    s_nop 1
    v_cndmask_b32 v220, 0, v220, vcc
    v_or_b32 v247, v247, v220
    v_pk_min_u16 v233, v233, v222
    v_cmp_le_u32 vcc, 2031616, v234
    v_mov_b32 v220, 4
    s_nop 1
    v_cndmask_b32 v220, 0, v220, vcc
    v_or_b32 v247, v247, v220
    v_pk_min_u16 v234, v234, v222
    v_cmp_le_u32 vcc, 2031616, v235
    v_mov_b32 v220, 8
    s_nop 1
    v_cndmask_b32 v220, 0, v220, vcc
    v_or_b32 v247, v247, v220
    v_pk_min_u16 v235, v235, v222
    v_cmp_ne_u32 vcc, 0, v247
    s_nop 3
    s_ff1_i32_b64 s3, vcc
    v_readlane_b32 s66, v247, s3
    s_lshl_b32 s3, s3, 2
    s_nop 3
    s_ff1_i32_b32 s66, s66
    s_add_u32 s3, s3, s66
    s_mul_i32 s66, s3, 25728
    v_lshlrev_b32 v220, 4, v1
    buffer_load_dword v254, v220, s[32:35], s66 offen sc1
    s_branch M_build
M_nofit:
    v_cmp_gt_u32 vcc, 512, v221
    s_mov_b32 s61, 1
    s_nop 3
    s_bcnt1_i32_b64 s3, vcc
    s_sub_u32 s3, s3, 1
    v_readlane_b32 s63, v221, s3
    s_nop 3
    s_min_u32 s63, s63, 511
    v_cndmask_b32 v212, 0, v212, vcc
    v_cndmask_b32 v232, v232, 0, vcc
    v_cndmask_b32 v213, 0, v213, vcc
    v_cndmask_b32 v233, v233, 0, vcc
    v_cndmask_b32 v214, 0, v214, vcc
    v_cndmask_b32 v234, v234, 0, vcc
    v_cndmask_b32 v215, 0, v215, vcc
    v_cndmask_b32 v235, v235, 0, vcc
    s_branch M_fit
M_ggather:
    buffer_load_dword v44, v44, s[36:39], 0 offen offset:0 sc1
    buffer_load_dword v45, v45, s[36:39], 0 offen offset:4 sc1
    buffer_load_dword v46, v46, s[36:39], 0 offen offset:8 sc1
    buffer_load_dword v47, v47, s[36:39], 0 offen offset:12 sc1
    buffer_load_dword v48, v48, s[36:39], 0 offen offset:16 sc1
    buffer_load_dword v49, v49, s[36:39], 0 offen offset:20 sc1
    buffer_load_dword v50, v50, s[36:39], 0 offen offset:24 sc1
    buffer_load_dword v51, v51, s[36:39], 0 offen offset:28 sc1
    s_waitcnt vmcnt(0) lgkmcnt(0)
    s_branch M_gathered
M_pad:
    v_add_u32 v220, s63, v1
    v_lshl_add_u32 v221, v220, 2, s54
    v_add_u32 v220, s73, v220
    v_mov_b32 v222, 0x3fff80
    v_mov_b32 v223, 0xff
    ds_write_b32 v221, v222 offset:0
    ds_write_b8 v220, v223 offset:0
    ds_write_b32 v221, v222 offset:256
    ds_write_b8 v220, v223 offset:64
    s_cmp_lg_u32 s62, 0
    s_cbranch_scc1 M_spec2
    ds_read2_b64 v[220:223], v243 offset0:0 offset1:8
    ds_read_b32 v236, v244 offset:0
    ds_read_u8 v237, v245 offset:0
    s_waitcnt lgkmcnt(0)
    s_add_u32 m0, s55, 0
    v_and_or_b32 v220, v220, s57, v238
    buffer_load_dwordx4 v220, s[24:27], 0 offen  lds
    s_add_u32 m0, s55, 1024
    v_and_or_b32 v221, v221, s57, v239
    buffer_load_dwordx4 v221, s[24:27], 0 offen  lds
    s_add_u32 m0, s55, 2048
    v_and_or_b32 v222, v222, s57, v238
    buffer_load_dwordx4 v222, s[24:27], 0 offen  lds
    s_add_u32 m0, s55, 3072
    v_and_or_b32 v223, v223, s57, v239
    buffer_load_dwordx4 v223, s[24:27], 0 offen  lds
    v_alignbit_b32 v236, v236, v236, 18
    v_and_or_b32 v236, v236, s59, v241
    v_mad_u32_u24 v236, v237, s60, v236
    buffer_load_dwordx4 v[196:199], v236, s[28:31], 0 offen
    ds_read2_b64 v[220:223], v243 offset0:16 offset1:24
    ds_read_b32 v236, v244 offset:128
    ds_read_u8 v237, v245 offset:32
    s_waitcnt lgkmcnt(0)
    s_add_u32 m0, s55, 4096
    v_and_or_b32 v220, v220, s57, v238
    buffer_load_dwordx4 v220, s[24:27], 0 offen  lds
    s_add_u32 m0, s55, 5120
    v_and_or_b32 v221, v221, s57, v239
    buffer_load_dwordx4 v221, s[24:27], 0 offen  lds
    s_add_u32 m0, s55, 6144
    v_and_or_b32 v222, v222, s57, v238
    buffer_load_dwordx4 v222, s[24:27], 0 offen  lds
    s_add_u32 m0, s55, 7168
    v_and_or_b32 v223, v223, s57, v239
    buffer_load_dwordx4 v223, s[24:27], 0 offen  lds
    v_alignbit_b32 v236, v236, v236, 18
    v_and_or_b32 v236, v236, s59, v241
    v_mad_u32_u24 v236, v237, s60, v236
    buffer_load_dwordx4 v[200:203], v236, s[28:31], 0 offen
    s_branch M_pf2
M_special:
    s_cmp_lg_u32 s64, 0
    s_cbranch_scc1 M_ovf
M_spec2:
    s_barrier
    s_lshl_b32 s3, s63, 3
    s_or_b32 s3, s3, s52
    s_or_b32 s66, s61, s64
    s_lshl_b32 s66, s66, 31
    s_or_b32 s3, s3, s66
    v_mov_b32 v223, s3
    ds_write_b32 v59, v223 offset:448
    s_waitcnt lgkmcnt(0)
    s_barrier
    ds_read_b32 v54, v56 offset:448
    ds_read_b32 v55, v57 offset:448
    s_waitcnt lgkmcnt(0)
    v_cmp_gt_u32 vcc, v55, v54
    v_cmp_gt_i32 s[66:67], 0, v55
    s_lshl_b32 s3, s52, 3
    v_lshrrev_b64 v[222:223], v243, vcc
    v_and_b32 v222, 0xff, v222
    v_bcnt_u32_b32 v222, v222, 0
    v_cmp_eq_u32 vcc, s76, v222
    s_ff1_i32_b64 s68, vcc
    s_cmp_lg_u64 s[66:67], 0
    s_cselect_b32 s44, s3, s68
    v_readlane_b32 s45, v54, s44
    s_nop 3
    s_branch M_key
M_again:
    s_waitcnt vmcnt(0)
    s_nop 7
    s_sub_u32 s65, s65, 1
    s_cbranch_scc1 M_fin
    v_and_b32 v243, 0x38, v1
    v_and_b32 v220, 7, v1
    v_bfe_u32 v245, v1, 3, 1
    v_lshl_or_b32 v245, v220, 1, v245
    v_and_b32 v220, 16, v1
    v_or_b32 v245, v245, v220
    v_lshlrev_b32 v244, 2, v245
    v_or_b32 v246, v242, v220
    v_bfe_u32 v220, v1, 2, 1
    v_lshl_or_b32 v246, v220, 3, v246
    v_bfe_u32 v220, v1, 3, 1
    v_lshl_or_b32 v246, v220, 2, v246
    v_add_u32 v243, s54, v243
    v_add_u32 v244, s54, v244
    v_add_u32 v245, s73, v245
    v_add_u32 v246, s54, v246
    s_mov_b32 s63, 0
    s_cmp_eq_u32 s61, 0
    s_cbranch_scc1 M_ovf
    s_mov_b32 s61, 0
    s_mov_b32 s75, 16773120
    v_lshlrev_b32 v52, 5, v1
    v_add_u32 v53, s54, v52
    v_lshl_add_u32 v58, v1, 3, s73
    v_subrev_u32 v52, 2048, v52
    v_mov_b32 v184, 0
    v_mov_b32 v185, 0
    v_mov_b32 v186, 0
    v_mov_b32 v187, 0
    v_mov_b32 v56, 0
    v_mov_b32 v57, 0
    v_mov_b32 v59, 0
    ds_write_b128 v53, v[184:187]
    ds_write_b128 v53, v[184:187] offset:16
    v_and_b32 v224, 31, v1
    v_lshlrev_b32 v224, 8, v224
    v_lshl_add_u32 v224, v241, 3, v224
    v_lshl_or_b32 v222, v1, 18, v224
    v_add_u32 v204, 514, v222
    v_add_u32 v205, 66082, v222
    v_add_u32 v206, 131650, v222
    v_add_u32 v207, 197218, v222
    s_branch M_build
M_ovf:
    s_cmp_gt_u32 s63, 512
    s_cbranch_scc1 M_pad
    s_cmp_lt_u32 s71, s72
    s_cbranch_scc1 M_ovfl
    v_cmp_ne_u32 vcc, 0, v247
    s_nop 3
    s_cmp_lg_u64 vcc, 0
    s_cbranch_scc1 M_ovfn
    s_mov_b32 s64, 0
    s_branch M_pad
M_ovfn:
    s_ff1_i32_b64 s3, vcc
    v_readlane_b32 s71, v247, s3
    s_lshl_b32 s70, s3, 2
    s_nop 3
    s_ff1_i32_b32 s72, s71
    s_bitset0_b32 s71, s72
    s_mov_b32 m0, s3
    s_nop 0
    v_writelane_b32 v247, s71, m0
    s_add_u32 s70, s70, s72
    s_mov_b32 s71, 0
M_ovfl:
    s_mul_i32 s3, s70, 25728
    v_mov_b32 v222, 0
    buffer_load_dword v222, v222, s[32:35], s3 offen sc1
    v_add_u32 v220, s71, v1
    v_lshlrev_b32 v221, 3, v220
    buffer_load_dwordx2 v[226:227], v221, s[32:35], s3 offen offset:8 sc1
    v_mov_b32 v223, s70
    s_waitcnt vmcnt(0)
    v_readfirstlane_b32 s72, v222
    v_cmp_eq_u32 vcc, s53, v227
    s_nop 3
    s_min_u32 s72, s72, 3200
    v_cmp_gt_u32 s[66:67], s72, v220
    s_nop 3
    s_and_b64 vcc, vcc, s[66:67]
    v_mbcnt_lo_u32_b32 v220, vcc_lo, 0
    v_mbcnt_hi_u32_b32 v220, vcc_hi, v220
    v_add_u32 v220, s63, v220
    v_lshl_add_u32 v221, v220, 2, s54
    v_add_u32 v220, s73, v220
    s_mov_b64 exec, vcc
    ds_write_b32 v221, v226
    ds_write_b8 v220, v223
    s_mov_b64 exec, -1
    s_bcnt1_i32_b64 s3, vcc
    s_add_u32 s63, s63, s3
    s_add_u32 s71, s71, 64
    s_branch M_ovf
M_codeend:

.section .rodata,"a"
.p2align 6
.amdhsa_kernel gather_scatter__edge_featured_mpnn_egc__graph_kernel
  .amdhsa_next_free_vgpr 255
  .amdhsa_next_free_sgpr 80
  .amdhsa_accum_offset 256
  .amdhsa_group_segment_fixed_size 0
  .amdhsa_kernarg_size 80
  .amdhsa_user_sgpr_count 2
  .amdhsa_user_sgpr_kernarg_segment_ptr 1
  .amdhsa_system_sgpr_workgroup_id_x 1
  .amdhsa_float_denorm_mode_32 3
.end_amdhsa_kernel
```
